```python
import torch

def _softmax(x, axis=-1):
    return torch.softmax(x, dim=axis)
def _gelu(x):
    return torch.nn.functional.gelu(x, approximate="tanh")
def _silu(x):
    return torch.nn.functional.silu(x)
def _sigmoid(x):
    return torch.sigmoid(x)
def _layernorm(x, axis=-1, eps=1e-5):
    m = x.mean(dim=axis, keepdim=True)
    v = x.var(dim=axis, keepdim=True, unbiased=False)
    return (x - m) / torch.sqrt(v + eps)
def _scatter_add(tgt, idx, src, axis=0):
    return tgt.clone().index_add_(axis, idx, src)
def _segment_sum(src, seg, n):
    out = torch.zeros((n,) + src.shape[1:], dtype=src.dtype)
    return out.index_add_(0, seg, src)
def _pad(x, pw):
    flat = tuple(v for pair in reversed(pw) for v in pair)
    return torch.nn.functional.pad(x, flat)

kernel_name = 'parallel_sum__ssm_conv_s4__dense_activation_silu__prompt'

def setup_inputs():

    _w = (lambda a: (lambda t: t.to(torch.bfloat16) if t.is_floating_point() else t)(torch.as_tensor(a)))
    def _A_setup():
        B, L, D, N = 1, 2048, 512, 128
        A_re = -(lambda _x: torch.exp(torch.as_tensor(_x)))((lambda *s: torch.randn(*s, dtype=torch.bfloat16) * 6.4)(D, N))
        A_im = torch.pi * (lambda *s: torch.randn(*s, dtype=torch.bfloat16) * 0.05)(D, N)
        B_re = (lambda *s: torch.randn(*s, dtype=torch.bfloat16) * 0.1)(D, N)
        B_im = (lambda *s: torch.randn(*s, dtype=torch.bfloat16) * 0.1)(D, N)
        C_re = (lambda *s: torch.randn(*s, dtype=torch.bfloat16) * 0.1)(D, N)
        C_im = (lambda *s: torch.randn(*s, dtype=torch.bfloat16) * 0.1)(D, N)
        log_dt = (lambda *s: torch.randn(*s, dtype=torch.bfloat16) * 0.05)(D) * 0.5 - 4.0
        Dskip = (lambda *s: torch.randn(*s, dtype=torch.bfloat16) * 0.05)(D)
        return {
            "u": _w((lambda *s: torch.randn(*s, dtype=torch.bfloat16) * 0.05)(B, L, D)),
            "A_re": _w(A_re),
            "A_im": _w(A_im),
            "B_re": _w(B_re),
            "B_im": _w(B_im),
            "C_re": _w(C_re),
            "C_im": _w(C_im),
            "log_dt": _w(log_dt),
            "Dskip": _w(Dskip),
        }
    _A_in = _A_setup()

    def _B_setup():
        B, S, D, F = 1, 2048, 512, 1376
        return {
            "x": _w((lambda *s: torch.randn(*s, dtype=torch.bfloat16) * 0.05)(B, S, D)),
            "w1": _w((lambda *s: torch.randn(*s, dtype=torch.bfloat16) * 0.8)(D, F) * (D ** -0.5)),
            "w2": _w((lambda *s: torch.randn(*s, dtype=torch.bfloat16) * 0.2)(F, D) * (F ** -0.5)),
        }
    _B_in = _B_setup()

    return {
        "A_u": _A_in["u"],
        "A_A_re": _A_in["A_re"],
        "A_A_im": _A_in["A_im"],
        "A_B_re": _A_in["B_re"],
        "A_B_im": _A_in["B_im"],
        "A_C_re": _A_in["C_re"],
        "A_C_im": _A_in["C_im"],
        "A_log_dt": _A_in["log_dt"],
        "A_Dskip": _A_in["Dskip"],
        "B_x": _B_in["x"],
        "B_w1": _B_in["w1"],
        "B_w2": _B_in["w2"],
    }

def reference(A_u, A_A_re, A_A_im, A_B_re, A_B_im, A_C_re, A_C_im, A_log_dt, A_Dskip, B_x, B_w1, B_w2):
    def _A_ref(u, A_re, A_im, B_re, B_im, C_re, C_im, log_dt, Dskip):
        Bsz, L, D = u.shape
        dt = torch.exp(log_dt)[:, None]
        A = A_re + 1j * A_im
        Bc = B_re + 1j * B_im
        Cc = C_re + 1j * C_im
        logdA = dt * A
        dB = dt * Bc
        l = (lambda x, dt: x.to(dt))(torch.arange(L), A_re.dtype)
        P = torch.exp(logdA[:, :, None] * l[None, None, :])
        K = torch.einsum("dn,dnl,dn->dl", Cc, P, dB).real
        L2 = 2 * L
        Kp = _pad(K, ((0, 0), (0, L)))
        up = (lambda x, *d: x.permute(*d))(u, 0, 2, 1)
        up = _pad(up, ((0, 0), (0, 0), (0, L)))
        Kf = (lambda x, axes=(-2,-1): torch.fft.rfft2(x.float(), dim=axes))(Kp[:, None, :], axes=(-2, -1))
        Uf = (lambda x, axes=(-2,-1): torch.fft.rfft2(x.float(), dim=axes))(up[:, :, None, :], axes=(-2, -1))
        Yf = Uf * Kf[None, :, :, :]
        y = (lambda x, s, axes=(-2,-1): torch.fft.irfft2(x, s=s, dim=axes).to(torch.bfloat16))(Yf, (1, L2), axes=(-2, -1))[:, :, 0, :L]
        y = (lambda x, *d: x.permute(*d))(y, 0, 2, 1) + u * Dskip[None, None, :]
        return y

    def _B_ref(x, w1, w2):
        h = torch.einsum("bsd,df->bsf", x, w1)
        h = _silu(h)
        out = torch.einsum("bsf,fd->bsd", h, w2)
        return out

    x = A_u
    xn = _layernorm(x, axis=-1)
    return x + _A_ref(xn, A_A_re, A_A_im, A_B_re, A_B_im, A_C_re, A_C_im, A_log_dt, A_Dskip) + _B_ref(xn, B_w1, B_w2)
```

```asm
; @launch grid=(256,1,1) block=(512,1,1) lds=163840
.amdgcn_target "amdgcn-amd-amdhsa--gfx950"
.text
.globl parallel_sum__ssm_conv_s4__dense_activation_silu__prompt_kernel
.p2align 8
.type parallel_sum__ssm_conv_s4__dense_activation_silu__prompt_kernel,@function
parallel_sum__ssm_conv_s4__dense_activation_silu__prompt_kernel:
  v_lshrrev_b32 v1, 6, v0
  s_cmp_ge_u32 s2, 256
  s_cbranch_scc1 L_exit
  v_readfirstlane_b32 s32, v1
  s_and_b32 s3, s2, 7
  s_lshl_b32 s3, s3, 5
  s_lshr_b32 s96, s2, 3
  s_add_u32 s3, s3, s96
  s_cmp_lt_u32 s32, 4
  s_cbranch_scc1 L_gemm
  s_getpc_b64 s[94:95]
  s_lshl_b32 s96, s96, 10
  v_and_b32 v255, 7, v0
  v_lshl_add_u32 v255, v255, 7, s96
  v_min_u32 v255, L_exit-parallel_sum__ssm_conv_s4__dense_activation_silu__prompt_kernel-128, v255
  v_mov_b32 v253, s95
  v_add_co_u32 v252, vcc, s94, v255
  s_nop 1
  v_addc_co_u32 v253, vcc, 0, v253, vcc
  global_load_dword v254, v[252:253], off
  s_load_dwordx16 s[16:31], s[0:1], 0
  s_load_dwordx2 s[8:9], s[0:1], 104
  s_load_dwordx2 s[52:53], s[0:1], 64
  s_load_dwordx2 s[92:93], s[0:1], 88
  s_load_dwordx2 s[88:89], s[0:1], 80
  s_load_dwordx2 s[12:13], s[0:1], 112
  s_memrealtime s[36:37]
  s_setprio 3
  s_sub_u32 s32, s32, 4
  v_and_b32 v1, 63, v0
  v_and_b32 v54, 255, v0
  s_lshl_b32 s7, s3, 9
  v_lshl_add_u32 v56, v54, 1, s7
  s_lshl2_add_u32 s34, s3, s32
  s_lshl_b32 s34, s34, 11
  v_lshlrev_b32 v60, 4, v1
  v_lshl_add_u32 v57, v1, 6, s34
  s_lshl_b32 s7, s3, 2
  s_mov_b32 s10, 256
  s_mov_b32 s11, 0x20000
  s_waitcnt lgkmcnt(0)
  s_or_b32 s36, s36, 1
  v_mov_b32 v52, s36
  v_mov_b32 v53, s37
  buffer_store_dwordx2 v[52:53], v57, s[8:11], 0 offen sc1
  global_load_ushort v44, v56, s[18:19]
  global_load_ushort v45, v56, s[20:21]
  global_load_ushort v46, v56, s[22:23]
  global_load_ushort v47, v56, s[24:25]
  global_load_ushort v48, v56, s[26:27]
  global_load_ushort v49, v56, s[28:29]
  s_load_dword s42, s[30:31], s7
  s_load_dword s43, s[52:53], s7
  s_setprio 0
  s_branch L_ssm
L_gemm:
  s_load_dwordx2 s[4:5], s[0:1], 0
  s_load_dwordx2 s[8:9], s[0:1], 80
  s_load_dwordx2 s[24:25], s[0:1], 104
  s_load_dwordx2 s[12:13], s[0:1], 112
  s_load_dwordx2 s[16:17], s[0:1], 88
  s_load_dwordx2 s[20:21], s[0:1], 96
  v_and_b32 v1, 63, v0
  s_bfe_u32 s39, s2, 0x20001
  s_bfe_u32 s45, s2, 0x20003
  s_lshl2_add_u32 s33, s39, s45
  s_and_b32 s39, s2, 1
  s_bfe_u32 s37, s2, 0x30005
  s_lshl3_add_u32 s34, s39, s37
  s_and_b32 s39, s2, 6
  s_add_u32 s37, s37, s39
  s_and_b32 s37, s37, 7
  s_mov_b32 s96, s37
  v_lshlrev_b32 v22, 4, v1
  s_lshl2_add_u32 s48, s3, s32
  s_lshl_b32 s48, s48, 11
  s_setprio 2
  s_mov_b32 s6, 2097152
  s_mov_b32 s7, 0x20000
  s_mov_b32 s10, 1409024
  s_mov_b32 s11, 0x20000
  v_lshrrev_b32 v23, 3, v1
  v_lshlrev_b32 v23, 10, v23
  v_lshrrev_b32 v29, 4, v1
  v_xor_b32 v29, v29, v1
  v_and_b32 v29, 7, v29
  v_lshl_add_u32 v2, v29, 4, v23
  v_xor_b32 v3, 64, v2
  v_add_u32 v4, 14336, v2
  v_add_u32 v5, 21504, v3
  v_add_u32 v3, 7168, v3
  s_movk_i32 s39, 5462
  s_movk_i32 s45, 2560
  v_mul_u32_u24 v23, s39, v1
  v_lshrrev_b32 v29, 16, v23
  v_mad_u32_u24 v6, v29, s45, v22
  v_add_u32 v23, 349568, v23
  v_lshrrev_b32 v29, 16, v23
  v_mad_u32_u24 v7, v29, s45, v22
  v_add_u32 v23, 349568, v23
  v_lshrrev_b32 v29, 16, v23
  v_mad_u32_u24 v8, v29, s45, v22
  s_lshl2_add_u32 s35, s33, s32
  s_lshl_b32 s35, s35, 15
  s_mul_i32 s36, s34, 192
  s_mul_i32 s39, s32, 44032
  s_add_u32 s36, s36, s39
  s_lshr_b32 s49, s35, 6
  s_cmp_eq_u32 s34, 15
  s_cselect_b32 s35, 1073741824, s35
  s_cselect_b32 s36, 1073741824, s36
  s_lshl_b32 s40, s32, 12
  s_mul_i32 s41, s32, 3072
  s_add_u32 s41, s41, 49152
  s_waitcnt lgkmcnt(0)
  buffer_load_dwordx4 v[224:227], v22, s[4:7], s48 offen offset:0
  buffer_load_dwordx4 v[228:231], v22, s[4:7], s48 offen offset:1024
  s_mov_b32 s54, 0x3f803f80
  s_mov_b32 s55, 0xffff0000
  s_mul_i32 s46, s32, 2112
  s_add_u32 s46, s46, 98304
  v_add_u32 v92, s46, v22
  v_bfe_u32 v95, v1, 2, 2
  v_and_b32 v23, 1, v1
  v_lshl_add_u32 v23, v23, 2, v95
  v_mul_u32_u24 v23, 1056, v23
  v_and_b32 v29, 2, v1
  v_lshl_add_u32 v23, v29, 2, v23
  v_lshrrev_b32 v29, 4, v1
  v_lshl_add_u32 v23, v29, 4, v23
  s_lshl_b32 s46, s32, 8
  s_add_u32 s46, s46, 98304
  v_add_u32 v93, s46, v23
  s_mul_i32 s45, s37, 176128
  s_add_u32 m0, s41, 0
  s_add_u32 s45, s45, s36
  buffer_load_dwordx4 v6, s[8:11], s45 offen offset:0  lds
  s_add_u32 s37, s37, 1
  s_and_b32 s37, s37, 7
  buffer_load_dwordx4 v7, s[8:11], s45 offen offset:1024  lds
  buffer_load_dwordx4 v8, s[8:11], s45 offen offset:2048  lds
  s_lshl_b32 s38, s96, 7
  s_add_u32 m0, s40, 0
  s_add_u32 s38, s38, s35
  buffer_load_dwordx4 v2, s[4:7], s38 offen offset:0 lds
  s_add_u32 s96, s96, 1
  s_and_b32 s96, s96, 7
  buffer_load_dwordx4 v3, s[4:7], s38 offen offset:1024 lds
  buffer_load_dwordx4 v4, s[4:7], s38 offen offset:2048 lds
  buffer_load_dwordx4 v5, s[4:7], s38 offen offset:3072 lds
  v_and_b32 v31, 31, v1
  v_lshrrev_b32 v29, 5, v1
  v_bfe_u32 v30, v1, 1, 3
  v_xor_b32 v30, v30, v29
  v_lshl_add_u32 v30, v30, 4, s40
  v_lshl_add_u32 v30, v31, 7, v30
  v_bfe_u32 v95, v1, 2, 2
  v_lshl_add_u32 v23, v29, 3, v95
  v_mul_u32_u24 v23, 192, v23
  v_bfe_u32 v29, v1, 4, 1
  v_lshl_add_u32 v23, v29, 5, v23
  v_and_b32 v29, 3, v1
  v_lshl_add_u32 v23, v29, 3, v23
  v_add_u32 v23, 49152, v23
  s_add_u32 s46, s32, 0
  s_and_b32 s46, s46, 3
  s_lshl_b32 s48, s46, 5
  s_mulk_i32 s46, 3072
  v_xor_b32 v9, s48, v30
  v_add_u32 v13, s46, v23
  s_add_u32 s46, s32, 1
  s_and_b32 s46, s46, 3
  s_lshl_b32 s48, s46, 5
  s_mulk_i32 s46, 3072
  v_xor_b32 v10, s48, v30
  v_add_u32 v14, s46, v23
  s_add_u32 s46, s32, 2
  s_and_b32 s46, s46, 3
  s_lshl_b32 s48, s46, 5
  s_mulk_i32 s46, 3072
  v_xor_b32 v11, s48, v30
  v_add_u32 v15, s46, v23
  s_add_u32 s46, s32, 3
  s_and_b32 s46, s46, 3
  s_lshl_b32 s48, s46, 5
  s_mulk_i32 s46, 3072
  v_xor_b32 v12, s48, v30
  v_add_u32 v16, s46, v23
  s_mul_i32 s45, s37, 176128
  s_add_u32 m0, s41, 12288
  s_add_u32 s45, s45, s36
  buffer_load_dwordx4 v6, s[8:11], s45 offen offset:0  lds
  s_add_u32 s37, s37, 1
  s_and_b32 s37, s37, 7
  buffer_load_dwordx4 v7, s[8:11], s45 offen offset:1024  lds
  buffer_load_dwordx4 v8, s[8:11], s45 offen offset:2048  lds
  v_lshrrev_b32 v29, 4, v1
  s_mov_b32 s26, 256
  s_mov_b32 s27, 0x20000
  s_mov_b32 s14, 16777216
  s_mov_b32 s15, 0x20000
  v_lshrrev_b32 v23, 2, v1
  v_xor_b32 v23, v23, v29
  v_and_b32 v23, 1, v23
  v_add_u32 v23, -1, v23
  v_and_b32 v88, s54, v23
  v_and_b32 v89, s54, v23
  v_and_b32 v90, s54, v23
  v_and_b32 v91, s54, v23
  s_add_u32 s37, s37, 2
  s_and_b32 s37, s37, 7
  s_add_u32 s96, s96, 2
  s_and_b32 s96, s96, 7
  s_waitcnt vmcnt(10)
  v_dot2_f32_bf16 v252, v224, s54, 0
  v_dot2_f32_bf16 v253, v228, s54, 0
  v_dot2_f32_bf16 v252, v225, s54, v252
  v_dot2_f32_bf16 v253, v229, s54, v253
  v_dot2_f32_bf16 v252, v226, s54, v252
  v_dot2_f32_bf16 v253, v230, s54, v253
  v_dot2_f32_bf16 v252, v227, s54, v252
  v_dot2_f32_bf16 v253, v231, s54, v253
  v_lshlrev_b32 v232, 16, v224
  v_and_b32 v233, s55, v224
  v_lshlrev_b32 v234, 16, v225
  v_add_f32_dpp v252, v252, v252 row_shr:1 row_mask:0xf bank_mask:0xf bound_ctrl:0
  v_add_f32_dpp v253, v253, v253 row_shr:1 row_mask:0xf bank_mask:0xf bound_ctrl:0
  v_and_b32 v235, s55, v225
  v_lshlrev_b32 v236, 16, v226
  v_and_b32 v237, s55, v226
  v_add_f32_dpp v252, v252, v252 row_shr:2 row_mask:0xf bank_mask:0xf bound_ctrl:0
  v_add_f32_dpp v253, v253, v253 row_shr:2 row_mask:0xf bank_mask:0xf bound_ctrl:0
  v_lshlrev_b32 v238, 16, v227
  v_and_b32 v239, s55, v227
  v_lshlrev_b32 v240, 16, v228
  v_add_f32_dpp v252, v252, v252 row_shr:4 row_mask:0xf bank_mask:0xf bound_ctrl:0
  v_add_f32_dpp v253, v253, v253 row_shr:4 row_mask:0xf bank_mask:0xf bound_ctrl:0
  v_and_b32 v241, s55, v228
  v_lshlrev_b32 v242, 16, v229
  v_and_b32 v243, s55, v229
  v_add_f32_dpp v252, v252, v252 row_shr:8 row_mask:0xf bank_mask:0xf bound_ctrl:0
  v_add_f32_dpp v253, v253, v253 row_shr:8 row_mask:0xf bank_mask:0xf bound_ctrl:0
  v_lshlrev_b32 v244, 16, v230
  v_and_b32 v245, s55, v230
  v_lshlrev_b32 v246, 16, v231
  v_add_f32_dpp v252, v252, v252 row_bcast:15 row_mask:0xa bank_mask:0xf
  v_add_f32_dpp v253, v253, v253 row_bcast:15 row_mask:0xa bank_mask:0xf
  v_and_b32 v247, s55, v231
  v_add_f32_dpp v252, v252, v252 row_bcast:31 row_mask:0xc bank_mask:0xf
  v_add_f32_dpp v253, v253, v253 row_bcast:31 row_mask:0xc bank_mask:0xf
  v_mul_f32 v252, 0x3b000000, v252
  v_mul_f32 v253, 0x3b000000, v253
  v_cvt_pk_bf16_f32 v254, -v252, -v252
  v_cvt_pk_bf16_f32 v255, -v253, -v253
  v_readlane_b32 s88, v252, 63
  v_readlane_b32 s90, v253, 63
  v_readlane_b32 s93, v254, 63
  v_readlane_b32 s95, v255, 63
  v_pk_add_f32 v[144:145], v[232:233], s[88:89] op_sel_hi:[1,0] neg_lo:[0,1] neg_hi:[0,1]
  v_pk_add_f32 v[152:153], v[240:241], s[90:91] op_sel_hi:[1,0] neg_lo:[0,1] neg_hi:[0,1]
  v_pk_add_f32 v[146:147], v[234:235], s[88:89] op_sel_hi:[1,0] neg_lo:[0,1] neg_hi:[0,1]
  v_pk_add_f32 v[154:155], v[242:243], s[90:91] op_sel_hi:[1,0] neg_lo:[0,1] neg_hi:[0,1]
  v_pk_add_f32 v[148:149], v[236:237], s[88:89] op_sel_hi:[1,0] neg_lo:[0,1] neg_hi:[0,1]
  v_pk_add_f32 v[156:157], v[244:245], s[90:91] op_sel_hi:[1,0] neg_lo:[0,1] neg_hi:[0,1]
  v_pk_add_f32 v[150:151], v[238:239], s[88:89] op_sel_hi:[1,0] neg_lo:[0,1] neg_hi:[0,1]
  v_pk_add_f32 v[158:159], v[246:247], s[90:91] op_sel_hi:[1,0] neg_lo:[0,1] neg_hi:[0,1]
  s_and_b32 s92, s93, s55
  s_and_b32 s94, s95, s55
  v_pk_mul_f32 v[144:145], v[144:145], v[144:145]
  v_pk_mul_f32 v[152:153], v[152:153], v[152:153]
  v_pk_fma_f32 v[144:145], v[146:147], v[146:147], v[144:145]
  v_pk_fma_f32 v[152:153], v[154:155], v[154:155], v[152:153]
  v_pk_fma_f32 v[144:145], v[148:149], v[148:149], v[144:145]
  v_pk_fma_f32 v[152:153], v[156:157], v[156:157], v[152:153]
  v_pk_fma_f32 v[144:145], v[150:151], v[150:151], v[144:145]
  v_pk_fma_f32 v[152:153], v[158:159], v[158:159], v[152:153]
  v_add_f32 v252, v144, v145
  v_add_f32 v253, v152, v153
  s_nop 0
  v_add_f32_dpp v252, v252, v252 row_shr:1 row_mask:0xf bank_mask:0xf bound_ctrl:0
  v_add_f32_dpp v253, v253, v253 row_shr:1 row_mask:0xf bank_mask:0xf bound_ctrl:0
  v_pk_add_f32 v[232:233], v[232:233], s[92:93] op_sel_hi:[1,0]
  v_pk_add_f32 v[240:241], v[240:241], s[94:95] op_sel_hi:[1,0]
  v_pk_add_f32 v[234:235], v[234:235], s[92:93] op_sel_hi:[1,0]
  v_add_f32_dpp v252, v252, v252 row_shr:2 row_mask:0xf bank_mask:0xf bound_ctrl:0
  v_add_f32_dpp v253, v253, v253 row_shr:2 row_mask:0xf bank_mask:0xf bound_ctrl:0
  v_pk_add_f32 v[242:243], v[242:243], s[94:95] op_sel_hi:[1,0]
  v_pk_add_f32 v[236:237], v[236:237], s[92:93] op_sel_hi:[1,0]
  v_pk_add_f32 v[244:245], v[244:245], s[94:95] op_sel_hi:[1,0]
  v_add_f32_dpp v252, v252, v252 row_shr:4 row_mask:0xf bank_mask:0xf bound_ctrl:0
  v_add_f32_dpp v253, v253, v253 row_shr:4 row_mask:0xf bank_mask:0xf bound_ctrl:0
  v_pk_add_f32 v[238:239], v[238:239], s[92:93] op_sel_hi:[1,0]
  v_pk_add_f32 v[246:247], v[246:247], s[94:95] op_sel_hi:[1,0]
  v_cvt_pk_bf16_f32 v224, v232, v233
  v_add_f32_dpp v252, v252, v252 row_shr:8 row_mask:0xf bank_mask:0xf bound_ctrl:0
  v_add_f32_dpp v253, v253, v253 row_shr:8 row_mask:0xf bank_mask:0xf bound_ctrl:0
  v_cvt_pk_bf16_f32 v228, v240, v241
  v_cvt_pk_bf16_f32 v225, v234, v235
  v_cvt_pk_bf16_f32 v229, v242, v243
  v_add_f32_dpp v252, v252, v252 row_bcast:15 row_mask:0xa bank_mask:0xf
  v_add_f32_dpp v253, v253, v253 row_bcast:15 row_mask:0xa bank_mask:0xf
  v_cvt_pk_bf16_f32 v226, v236, v237
  v_cvt_pk_bf16_f32 v230, v244, v245
  v_cvt_pk_bf16_f32 v227, v238, v239
  v_add_f32_dpp v252, v252, v252 row_bcast:31 row_mask:0xc bank_mask:0xf
  v_add_f32_dpp v253, v253, v253 row_bcast:31 row_mask:0xc bank_mask:0xf
  v_cvt_pk_bf16_f32 v231, v246, v247
  v_mul_f32 v252, 0x3b000000, v252
  v_mul_f32 v253, 0x3b000000, v253
  v_cvt_pk_bf16_f32 v252, v252, v252
  v_cvt_pk_bf16_f32 v253, v253, v253
  v_lshlrev_b32 v252, 16, v252
  v_lshlrev_b32 v253, 16, v253
  v_add_f32 v252, 0x3727c5ac, v252
  v_add_f32 v253, 0x3727c5ac, v253
  v_cvt_pk_bf16_f32 v252, v252, v252
  v_cvt_pk_bf16_f32 v253, v253, v253
  v_lshlrev_b32 v252, 16, v252
  v_lshlrev_b32 v253, 16, v253
  v_sqrt_f32 v252, v252
  v_sqrt_f32 v253, v253
  v_cvt_pk_bf16_f32 v252, v252, v252
  v_cvt_pk_bf16_f32 v253, v253, v253
  v_lshlrev_b32 v252, 16, v252
  v_lshlrev_b32 v253, 16, v253
  v_rcp_f32 v252, v252
  v_rcp_f32 v253, v253
  v_lshlrev_b32 v232, 16, v224
  v_and_b32 v233, s55, v224
  v_lshlrev_b32 v234, 16, v225
  v_and_b32 v235, s55, v225
  v_lshlrev_b32 v236, 16, v226
  v_and_b32 v237, s55, v226
  v_lshlrev_b32 v238, 16, v227
  v_and_b32 v239, s55, v227
  v_lshlrev_b32 v240, 16, v228
  v_and_b32 v241, s55, v228
  v_lshlrev_b32 v242, 16, v229
  v_and_b32 v243, s55, v229
  v_lshlrev_b32 v244, 16, v230
  v_and_b32 v245, s55, v230
  v_lshlrev_b32 v246, 16, v231
  v_and_b32 v247, s55, v231
  v_readlane_b32 s88, v252, 63
  v_readlane_b32 s90, v253, 63
  s_load_dwordx2 s[50:51], s[24:25], 0
  v_pk_mul_f32 v[232:233], v[232:233], s[88:89] op_sel_hi:[1,0]
  v_pk_mul_f32 v[234:235], v[234:235], s[88:89] op_sel_hi:[1,0]
  v_pk_mul_f32 v[236:237], v[236:237], s[88:89] op_sel_hi:[1,0]
  v_pk_mul_f32 v[238:239], v[238:239], s[88:89] op_sel_hi:[1,0]
  v_cvt_pk_bf16_f32 v224, v232, v233
  v_cvt_pk_bf16_f32 v225, v234, v235
  v_cvt_pk_bf16_f32 v226, v236, v237
  v_cvt_pk_bf16_f32 v227, v238, v239
  ds_write_b128 v92, v[224:227] offset:0
  v_pk_mul_f32 v[240:241], v[240:241], s[90:91] op_sel_hi:[1,0]
  v_pk_mul_f32 v[242:243], v[242:243], s[90:91] op_sel_hi:[1,0]
  v_pk_mul_f32 v[244:245], v[244:245], s[90:91] op_sel_hi:[1,0]
  v_pk_mul_f32 v[246:247], v[246:247], s[90:91] op_sel_hi:[1,0]
  v_cvt_pk_bf16_f32 v228, v240, v241
  v_cvt_pk_bf16_f32 v229, v242, v243
  v_cvt_pk_bf16_f32 v230, v244, v245
  v_cvt_pk_bf16_f32 v231, v246, v247
  ds_write_b128 v92, v[228:231] offset:1056
  v_mov_b32 v248, s93
  v_mov_b32 v249, s88
  v_writelane_b32 v248, s95, 1
  v_writelane_b32 v249, s90, 1
  s_mul_i32 s89, s3, 18432
  s_lshl_b32 s46, s32, 12
  s_add_u32 s89, s89, s46
  s_add_u32 s89, s89, 6291456
  s_lshl2_add_u32 s90, s3, s32
  s_lshl_b32 s90, s90, 5
  s_add_u32 s90, s90, 5767168
  s_waitcnt lgkmcnt(0)
  s_waitcnt vmcnt(3)
  s_barrier
  ds_read_b128 v[192:195], v9 offset:0
  ds_read_b64_tr_b16 v[96:97], v13 offset:0
  ds_read_b64_tr_b16 v[98:99], v13 offset:768
  ds_read_b64_tr_b16 v[100:101], v13 offset:64
  ds_read_b64_tr_b16 v[102:103], v13 offset:832
  ds_read_b64_tr_b16 v[104:105], v13 offset:128
  ds_read_b64_tr_b16 v[106:107], v13 offset:896
  ds_read_b128 v[196:199], v10 offset:0
  ds_read_b128 v[200:203], v11 offset:0
  ds_read_b128 v[204:207], v12 offset:0
  ds_read_b64_tr_b16 v[108:109], v14 offset:0
  ds_read_b64_tr_b16 v[110:111], v14 offset:768
  ds_read_b64_tr_b16 v[112:113], v14 offset:64
  ds_read_b64_tr_b16 v[114:115], v14 offset:832
  ds_read_b64_tr_b16 v[116:117], v14 offset:128
  ds_read_b64_tr_b16 v[118:119], v14 offset:896
  s_cmp_eq_u32 s50, 0
  s_cbranch_scc1 G_tagslow
G_tagok:
  v_mov_b32 v234, s50
  v_mov_b32 v235, s51
  v_mov_b32 v238, s50
  v_mov_b32 v239, s51
  v_mov_b32 v242, s50
  v_mov_b32 v243, s51
  v_mov_b32 v246, s50
  v_mov_b32 v247, s51
  v_mov_b32 v250, s50
  v_mov_b32 v251, s51
  s_waitcnt lgkmcnt(9)
  v_mfma_f32_32x32x16_bf16 v[40:55], v[96:99], v[192:195], 0
  ds_read_b64_tr_b16 v[120:121], v15 offset:0
  ds_read_b64_tr_b16 v[122:123], v15 offset:768
  ds_read_b64_tr_b16 v[232:233], v93 offset:0
  ds_read_b64_tr_b16 v[236:237], v93 offset:64
  ds_read_b64_tr_b16 v[240:241], v93 offset:128
  ds_read_b64_tr_b16 v[244:245], v93 offset:192
  v_mfma_f32_16x16x32_bf16 v[144:147], v[88:91], v[96:99], 0
  v_mfma_f32_32x32x16_bf16 v[56:71], v[100:103], v[192:195], 0
  ds_read_b64_tr_b16 v[124:125], v15 offset:64
  ds_read_b64_tr_b16 v[126:127], v15 offset:832
  v_mfma_f32_16x16x32_bf16 v[148:151], v[88:91], v[100:103], 0
  v_mfma_f32_32x32x16_bf16 v[72:87], v[104:107], v[192:195], 0
  ds_read_b64_tr_b16 v[128:129], v15 offset:128
  ds_read_b64_tr_b16 v[130:131], v15 offset:896
  v_mfma_f32_16x16x32_bf16 v[152:155], v[88:91], v[104:107], 0
  s_waitcnt lgkmcnt(10)
  v_mfma_f32_32x32x16_bf16 v[40:55], v[108:111], v[196:199], v[40:55]
  ds_read_b64_tr_b16 v[96:97], v16 offset:0
  ds_read_b64_tr_b16 v[98:99], v16 offset:768
  s_lshl_b32 s38, s96, 7
  s_add_u32 m0, s40, 0
  s_add_u32 s38, s38, s35
  buffer_load_dwordx4 v2, s[4:7], s38 offen offset:0 lds
  s_add_u32 s96, s96, 1
  s_and_b32 s96, s96, 7
  v_mfma_f32_32x32x16_bf16 v[56:71], v[112:115], v[196:199], v[56:71]
  ds_read_b64_tr_b16 v[100:101], v16 offset:64
  ds_read_b64_tr_b16 v[102:103], v16 offset:832
  buffer_load_dwordx4 v3, s[4:7], s38 offen offset:1024 lds
  s_mov_b32 s18, 1409024
  s_mov_b32 s19, 0x20000
  s_mov_b32 s22, 2097152
  s_mov_b32 s23, 0x20000
  v_mfma_f32_32x32x16_bf16 v[72:87], v[116:119], v[196:199], v[72:87]
  ds_read_b64_tr_b16 v[104:105], v16 offset:128
  ds_read_b64_tr_b16 v[106:107], v16 offset:896
  buffer_load_dwordx4 v4, s[4:7], s38 offen offset:2048 lds
  s_mov_b32 s28, s12
  s_mov_b32 s29, s13
  s_mov_b32 s30, 5767168
  s_mov_b32 s31, 0x20000
  s_waitcnt vmcnt(3)
  s_barrier
  s_waitcnt lgkmcnt(6)
  v_mfma_f32_32x32x16_bf16 v[40:55], v[120:123], v[200:203], v[40:55]
  ds_read_b128 v[208:211], v9 offset:16384
  ds_read_b128 v[212:215], v10 offset:16384
  ds_read_b64_tr_b16 v[108:109], v13 offset:12288
  ds_read_b64_tr_b16 v[110:111], v13 offset:13056
  buffer_load_dwordx4 v5, s[4:7], s38 offen offset:3072 lds
  v_mfma_f32_32x32x16_bf16 v[56:71], v[124:127], v[200:203], v[56:71]
  ds_read_b128 v[216:219], v11 offset:16384
  ds_read_b64_tr_b16 v[112:113], v13 offset:12352
  ds_read_b64_tr_b16 v[114:115], v13 offset:13120
  v_mfma_f32_32x32x16_bf16 v[72:87], v[128:131], v[200:203], v[72:87]
  ds_read_b128 v[220:223], v12 offset:16384
  ds_read_b64_tr_b16 v[116:117], v13 offset:12416
  ds_read_b64_tr_b16 v[118:119], v13 offset:13184
  s_waitcnt lgkmcnt(10)
  v_mfma_f32_32x32x16_bf16 v[40:55], v[96:99], v[204:207], v[40:55]
  ds_read_b64_tr_b16 v[120:121], v14 offset:12288
  ds_read_b64_tr_b16 v[122:123], v14 offset:13056
  buffer_store_dwordx4 v[232:235], v22, s[12:15], s89 offen offset:0 sc1
  v_mfma_f32_32x32x16_bf16 v[56:71], v[100:103], v[204:207], v[56:71]
  ds_read_b64_tr_b16 v[124:125], v14 offset:12352
  ds_read_b64_tr_b16 v[126:127], v14 offset:13120
  buffer_store_dwordx4 v[236:239], v22, s[12:15], s89 offen offset:1024 sc1
  v_mfma_f32_32x32x16_bf16 v[72:87], v[104:107], v[204:207], v[72:87]
  ds_read_b64_tr_b16 v[128:129], v14 offset:12416
  ds_read_b64_tr_b16 v[130:131], v14 offset:13184
  buffer_store_dwordx4 v[240:243], v22, s[12:15], s89 offen offset:2048 sc1
  s_waitcnt lgkmcnt(6)
  v_mfma_f32_32x32x16_bf16 v[40:55], v[108:111], v[208:211], v[40:55]
  ds_read_b64_tr_b16 v[96:97], v15 offset:12288
  ds_read_b64_tr_b16 v[98:99], v15 offset:13056
  s_lshl_b32 s38, s96, 7
  s_add_u32 m0, s40, 16384
  s_add_u32 s38, s38, s35
  buffer_load_dwordx4 v2, s[4:7], s38 offen offset:0 lds
  s_add_u32 s96, s96, 1
  s_and_b32 s96, s96, 7
  v_mfma_f32_16x16x32_bf16 v[144:147], v[88:91], v[108:111], v[144:147]
  v_mfma_f32_32x32x16_bf16 v[56:71], v[112:115], v[208:211], v[56:71]
  ds_read_b64_tr_b16 v[100:101], v15 offset:12352
  ds_read_b64_tr_b16 v[102:103], v15 offset:13120
  buffer_load_dwordx4 v3, s[4:7], s38 offen offset:1024 lds
  v_mfma_f32_16x16x32_bf16 v[148:151], v[88:91], v[112:115], v[148:151]
  v_mfma_f32_32x32x16_bf16 v[72:87], v[116:119], v[208:211], v[72:87]
  ds_read_b64_tr_b16 v[104:105], v15 offset:12416
  ds_read_b64_tr_b16 v[106:107], v15 offset:13184
  buffer_load_dwordx4 v4, s[4:7], s38 offen offset:2048 lds
  v_mfma_f32_16x16x32_bf16 v[152:155], v[88:91], v[116:119], v[152:155]
  s_waitcnt lgkmcnt(6)
  v_mfma_f32_32x32x16_bf16 v[40:55], v[120:123], v[212:215], v[40:55]
  ds_read_b64_tr_b16 v[108:109], v16 offset:12288
  ds_read_b64_tr_b16 v[110:111], v16 offset:13056
  buffer_load_dwordx4 v5, s[4:7], s38 offen offset:3072 lds
  v_mfma_f32_32x32x16_bf16 v[56:71], v[124:127], v[212:215], v[56:71]
  ds_read_b64_tr_b16 v[112:113], v16 offset:12352
  ds_read_b64_tr_b16 v[114:115], v16 offset:13120
  s_mov_b32 s47, 0x3fb8aa3b
  v_lshlrev_b32 v31, 4, v31
  s_add_u32 s49, s49, 5767168
  v_lshrrev_b32 v23, 3, v1
  v_mfma_f32_32x32x16_bf16 v[72:87], v[128:131], v[212:215], v[72:87]
  ds_read_b64_tr_b16 v[116:117], v16 offset:12416
  ds_read_b64_tr_b16 v[118:119], v16 offset:13184
  v_lshlrev_b32 v23, 10, v23
  v_bfe_u32 v29, v1, 4, 1
  v_lshlrev_b32 v95, 2, v29
  v_xor_b32 v95, v95, v1
  s_barrier
  s_waitcnt lgkmcnt(6)
  v_mfma_f32_32x32x16_bf16 v[40:55], v[96:99], v[216:219], v[40:55]
  ds_read_b128 v[192:195], v9 offset:32768
  ds_read_b128 v[196:199], v10 offset:32768
  ds_read_b64_tr_b16 v[120:121], v13 offset:24576
  ds_read_b64_tr_b16 v[122:123], v13 offset:25344
  s_mul_i32 s45, s37, 176128
  s_add_u32 m0, s41, 0
  s_add_u32 s45, s45, s36
  buffer_load_dwordx4 v6, s[8:11], s45 offen offset:0  lds
  s_add_u32 s37, s37, 1
  s_and_b32 s37, s37, 7
  v_mfma_f32_32x32x16_bf16 v[56:71], v[100:103], v[216:219], v[56:71]
  ds_read_b128 v[200:203], v11 offset:32768
  ds_read_b64_tr_b16 v[124:125], v13 offset:24640
  ds_read_b64_tr_b16 v[126:127], v13 offset:25408
  buffer_load_dwordx4 v7, s[8:11], s45 offen offset:1024  lds
  v_mfma_f32_32x32x16_bf16 v[72:87], v[104:107], v[216:219], v[72:87]
  ds_read_b128 v[204:207], v12 offset:32768
  ds_read_b64_tr_b16 v[128:129], v13 offset:24704
  ds_read_b64_tr_b16 v[130:131], v13 offset:25472
  buffer_load_dwordx4 v8, s[8:11], s45 offen offset:2048  lds
  s_waitcnt lgkmcnt(10)
  v_mfma_f32_32x32x16_bf16 v[40:55], v[108:111], v[220:223], v[40:55]
  ds_read_b64_tr_b16 v[96:97], v14 offset:24576
  ds_read_b64_tr_b16 v[98:99], v14 offset:25344
  buffer_store_dwordx4 v[244:247], v22, s[12:15], s89 offen offset:3072 sc1
  v_mfma_f32_32x32x16_bf16 v[56:71], v[112:115], v[220:223], v[56:71]
  ds_read_b64_tr_b16 v[100:101], v14 offset:24640
  ds_read_b64_tr_b16 v[102:103], v14 offset:25408
  s_mov_b64 exec, 3
  buffer_store_dwordx4 v[248:251], v22, s[12:15], s90 offen sc1
  s_mov_b64 exec, -1
  v_mfma_f32_32x32x16_bf16 v[72:87], v[116:119], v[220:223], v[72:87]
  ds_read_b64_tr_b16 v[104:105], v14 offset:24704
  ds_read_b64_tr_b16 v[106:107], v14 offset:25472
  v_and_b32 v95, 7, v95
  v_lshl_add_u32 v17, v95, 4, v23
  v_lshrrev_b32 v23, 5, v1
  v_bfe_u32 v95, v1, 2, 2
  s_waitcnt lgkmcnt(6)
  v_mfma_f32_32x32x16_bf16 v[40:55], v[120:123], v[192:195], v[40:55]
  ds_read_b64_tr_b16 v[108:109], v15 offset:24576
  ds_read_b64_tr_b16 v[110:111], v15 offset:25344
  s_lshl_b32 s38, s96, 7
  s_add_u32 m0, s40, 32768
  s_add_u32 s38, s38, s35
  buffer_load_dwordx4 v2, s[4:7], s38 offen offset:0 lds
  s_add_u32 s96, s96, 1
  s_and_b32 s96, s96, 7
  v_mfma_f32_16x16x32_bf16 v[144:147], v[88:91], v[120:123], v[144:147]
  v_mfma_f32_32x32x16_bf16 v[56:71], v[124:127], v[192:195], v[56:71]
  ds_read_b64_tr_b16 v[112:113], v15 offset:24640
  ds_read_b64_tr_b16 v[114:115], v15 offset:25408
  buffer_load_dwordx4 v3, s[4:7], s38 offen offset:1024 lds
  v_mfma_f32_16x16x32_bf16 v[148:151], v[88:91], v[124:127], v[148:151]
  v_mfma_f32_32x32x16_bf16 v[72:87], v[128:131], v[192:195], v[72:87]
  ds_read_b64_tr_b16 v[116:117], v15 offset:24704
  ds_read_b64_tr_b16 v[118:119], v15 offset:25472
  buffer_load_dwordx4 v4, s[4:7], s38 offen offset:2048 lds
  v_mfma_f32_16x16x32_bf16 v[152:155], v[88:91], v[128:131], v[152:155]
  s_waitcnt lgkmcnt(6)
  v_mfma_f32_32x32x16_bf16 v[40:55], v[96:99], v[196:199], v[40:55]
  ds_read_b64_tr_b16 v[120:121], v16 offset:24576
  ds_read_b64_tr_b16 v[122:123], v16 offset:25344
  buffer_load_dwordx4 v5, s[4:7], s38 offen offset:3072 lds
  v_mfma_f32_32x32x16_bf16 v[56:71], v[100:103], v[196:199], v[56:71]
  ds_read_b64_tr_b16 v[124:125], v16 offset:24640
  ds_read_b64_tr_b16 v[126:127], v16 offset:25408
  v_lshl_add_u32 v23, v23, 2, v95
  v_lshlrev_b32 v23, 7, v23
  v_lshl_add_u32 v23, v29, 5, v23
  v_bfe_u32 v29, v1, 3, 1
  v_mfma_f32_32x32x16_bf16 v[72:87], v[104:107], v[196:199], v[72:87]
  ds_read_b64_tr_b16 v[128:129], v16 offset:24704
  ds_read_b64_tr_b16 v[130:131], v16 offset:25472
  v_lshl_add_u32 v23, v29, 6, v23
  v_and_b32 v29, 3, v1
  v_lshl_add_u32 v23, v29, 3, v23
  s_lshl_b32 s46, s32, 5
  s_waitcnt vmcnt(16)
  s_barrier
  s_waitcnt lgkmcnt(6)
  v_mfma_f32_32x32x16_bf16 v[40:55], v[108:111], v[200:203], v[40:55]
  ds_read_b128 v[208:211], v9 offset:0
  ds_read_b128 v[212:215], v10 offset:0
  ds_read_b64_tr_b16 v[96:97], v13 offset:36864
  ds_read_b64_tr_b16 v[98:99], v13 offset:37632
  s_mul_i32 s45, s37, 176128
  s_add_u32 m0, s41, 12288
  s_add_u32 s45, s45, s36
  buffer_load_dwordx4 v6, s[8:11], s45 offen offset:0  lds
  s_add_u32 s37, s37, 1
  s_and_b32 s37, s37, 7
  v_mfma_f32_32x32x16_bf16 v[56:71], v[112:115], v[200:203], v[56:71]
  ds_read_b128 v[216:219], v11 offset:0
  ds_read_b64_tr_b16 v[100:101], v13 offset:36928
  ds_read_b64_tr_b16 v[102:103], v13 offset:37696
  buffer_load_dwordx4 v7, s[8:11], s45 offen offset:1024  lds
  v_mfma_f32_32x32x16_bf16 v[72:87], v[116:119], v[200:203], v[72:87]
  ds_read_b128 v[220:223], v12 offset:0
  ds_read_b64_tr_b16 v[104:105], v13 offset:36992
  ds_read_b64_tr_b16 v[106:107], v13 offset:37760
  buffer_load_dwordx4 v8, s[8:11], s45 offen offset:2048  lds
  s_waitcnt lgkmcnt(10)
  v_mfma_f32_32x32x16_bf16 v[40:55], v[120:123], v[204:207], v[40:55]
  ds_read_b64_tr_b16 v[108:109], v14 offset:36864
  ds_read_b64_tr_b16 v[110:111], v14 offset:37632
  s_and_b32 s46, s46, 64
  v_xor_b32 v23, s46, v23
  v_xor_b32 v29, 64, v23
  v_add_u32 v18, s40, v23
  v_mfma_f32_32x32x16_bf16 v[56:71], v[124:127], v[204:207], v[56:71]
  ds_read_b64_tr_b16 v[112:113], v14 offset:36928
  ds_read_b64_tr_b16 v[114:115], v14 offset:37696
  v_add_u32 v19, s40, v29
  v_add_u32 v20, s41, v23
  v_add_u32 v21, s41, v29
  s_bfe_u32 s39, s2, 0x20001
  v_mfma_f32_32x32x16_bf16 v[72:87], v[128:131], v[204:207], v[72:87]
  ds_read_b64_tr_b16 v[116:117], v14 offset:36992
  ds_read_b64_tr_b16 v[118:119], v14 offset:37760
  s_bfe_u32 s46, s2, 0x30003
  s_lshl3_add_u32 s53, s39, s46
  s_and_b32 s39, s2, 1
  s_bfe_u32 s46, s2, 0x20006
  s_waitcnt lgkmcnt(6)
  v_mfma_f32_32x32x16_bf16 v[40:55], v[96:99], v[208:211], v[40:55]
  ds_read_b64_tr_b16 v[120:121], v15 offset:36864
  ds_read_b64_tr_b16 v[122:123], v15 offset:37632
  s_lshl_b32 s38, s96, 7
  s_add_u32 m0, s40, 0
  s_add_u32 s38, s38, s35
  buffer_load_dwordx4 v2, s[4:7], s38 offen offset:0 lds
  s_add_u32 s96, s96, 1
  s_and_b32 s96, s96, 7
  v_mfma_f32_16x16x32_bf16 v[144:147], v[88:91], v[96:99], v[144:147]
  v_mfma_f32_32x32x16_bf16 v[56:71], v[100:103], v[208:211], v[56:71]
  ds_read_b64_tr_b16 v[124:125], v15 offset:36928
  ds_read_b64_tr_b16 v[126:127], v15 offset:37696
  buffer_load_dwordx4 v3, s[4:7], s38 offen offset:1024 lds
  v_mfma_f32_16x16x32_bf16 v[148:151], v[88:91], v[100:103], v[148:151]
  v_mfma_f32_32x32x16_bf16 v[72:87], v[104:107], v[208:211], v[72:87]
  ds_read_b64_tr_b16 v[128:129], v15 offset:36992
  ds_read_b64_tr_b16 v[130:131], v15 offset:37760
  buffer_load_dwordx4 v4, s[4:7], s38 offen offset:2048 lds
  v_mfma_f32_16x16x32_bf16 v[152:155], v[88:91], v[104:107], v[152:155]
  s_waitcnt lgkmcnt(6)
  v_mfma_f32_32x32x16_bf16 v[40:55], v[108:111], v[212:215], v[40:55]
  ds_read_b64_tr_b16 v[96:97], v16 offset:36864
  ds_read_b64_tr_b16 v[98:99], v16 offset:37632
  buffer_load_dwordx4 v5, s[4:7], s38 offen offset:3072 lds
  v_mfma_f32_32x32x16_bf16 v[56:71], v[112:115], v[212:215], v[56:71]
  ds_read_b64_tr_b16 v[100:101], v16 offset:36928
  ds_read_b64_tr_b16 v[102:103], v16 offset:37696
  s_lshl2_add_u32 s56, s39, s46
  s_mul_i32 s42, s32, 360448
  s_lshl_b32 s39, s56, 7
  s_add_u32 s42, s42, s39
  v_mfma_f32_32x32x16_bf16 v[72:87], v[116:119], v[212:215], v[72:87]
  ds_read_b64_tr_b16 v[104:105], v16 offset:36992
  ds_read_b64_tr_b16 v[106:107], v16 offset:37760
  s_mul_i32 s44, s53, 180224
  s_mul_i32 s39, s32, 22528
  s_add_u32 s44, s44, s39
  s_lshl_b32 s46, s32, 8
  s_waitcnt vmcnt(13)
  s_barrier
  s_waitcnt lgkmcnt(6)
  v_mfma_f32_32x32x16_bf16 v[40:55], v[120:123], v[216:219], v[40:55]
  ds_read_b128 v[192:195], v9 offset:16384
  ds_read_b128 v[196:199], v10 offset:16384
  ds_read_b64_tr_b16 v[108:109], v13 offset:0
  ds_read_b64_tr_b16 v[110:111], v13 offset:768
  s_mul_i32 s45, s37, 176128
  s_add_u32 m0, s41, 24576
  s_add_u32 s45, s45, s36
  buffer_load_dwordx4 v6, s[8:11], s45 offen offset:0  lds
  s_add_u32 s37, s37, 1
  s_and_b32 s37, s37, 7
  v_mfma_f32_32x32x16_bf16 v[56:71], v[124:127], v[216:219], v[56:71]
  ds_read_b128 v[200:203], v11 offset:16384
  ds_read_b64_tr_b16 v[112:113], v13 offset:64
  ds_read_b64_tr_b16 v[114:115], v13 offset:832
  buffer_load_dwordx4 v7, s[8:11], s45 offen offset:1024  lds
  v_mfma_f32_32x32x16_bf16 v[72:87], v[128:131], v[216:219], v[72:87]
  ds_read_b128 v[204:207], v12 offset:16384
  ds_read_b64_tr_b16 v[116:117], v13 offset:128
  ds_read_b64_tr_b16 v[118:119], v13 offset:896
  buffer_load_dwordx4 v8, s[8:11], s45 offen offset:2048  lds
  s_waitcnt lgkmcnt(10)
  v_mfma_f32_32x32x16_bf16 v[40:55], v[96:99], v[220:223], v[40:55]
  ds_read_b64_tr_b16 v[120:121], v14 offset:0
  ds_read_b64_tr_b16 v[122:123], v14 offset:768
  s_add_u32 s46, s46, 49152
  v_lshl_add_u32 v29, v1, 2, s46
  v_lshl_add_u32 v23, v1, 2, s41
  s_lshl2_add_u32 s46, s33, s32
  v_mfma_f32_32x32x16_bf16 v[56:71], v[100:103], v[220:223], v[56:71]
  ds_read_b64_tr_b16 v[124:125], v14 offset:64
  ds_read_b64_tr_b16 v[126:127], v14 offset:832
  s_mul_i32 s46, s46, 90112
  s_mul_i32 s43, s34, 6144
  s_add_u32 s43, s43, s46
  s_add_u32 s59, s43, 4096
  v_mfma_f32_32x32x16_bf16 v[72:87], v[104:107], v[220:223], v[72:87]
  ds_read_b64_tr_b16 v[128:129], v14 offset:128
  ds_read_b64_tr_b16 v[130:131], v14 offset:896
  s_cmp_ge_u32 s34, 14
  s_cselect_b32 s59, 5767168, s59
  s_lshr_b32 s46, s32, 1
  s_lshl1_add_u32 s46, s33, s46
  s_lshl4_add_u32 s46, s46, s34
  s_waitcnt lgkmcnt(6)
  v_mfma_f32_32x32x16_bf16 v[40:55], v[108:111], v[192:195], v[40:55]
  ds_read_b64_tr_b16 v[96:97], v15 offset:0
  ds_read_b64_tr_b16 v[98:99], v15 offset:768
  s_lshl_b32 s38, s96, 7
  s_add_u32 m0, s40, 16384
  s_add_u32 s38, s38, s35
  buffer_load_dwordx4 v2, s[4:7], s38 offen offset:0 lds
  s_add_u32 s96, s96, 1
  s_and_b32 s96, s96, 7
  v_mfma_f32_16x16x32_bf16 v[144:147], v[88:91], v[108:111], v[144:147]
  v_mfma_f32_32x32x16_bf16 v[56:71], v[112:115], v[192:195], v[56:71]
  ds_read_b64_tr_b16 v[100:101], v15 offset:64
  ds_read_b64_tr_b16 v[102:103], v15 offset:832
  buffer_load_dwordx4 v3, s[4:7], s38 offen offset:1024 lds
  v_mfma_f32_16x16x32_bf16 v[148:151], v[88:91], v[112:115], v[148:151]
  v_mfma_f32_32x32x16_bf16 v[72:87], v[116:119], v[192:195], v[72:87]
  ds_read_b64_tr_b16 v[104:105], v15 offset:128
  ds_read_b64_tr_b16 v[106:107], v15 offset:896
  buffer_load_dwordx4 v4, s[4:7], s38 offen offset:2048 lds
  v_mfma_f32_16x16x32_bf16 v[152:155], v[88:91], v[116:119], v[152:155]
  s_waitcnt lgkmcnt(6)
  v_mfma_f32_32x32x16_bf16 v[40:55], v[120:123], v[196:199], v[40:55]
  ds_read_b64_tr_b16 v[108:109], v16 offset:0
  ds_read_b64_tr_b16 v[110:111], v16 offset:768
  buffer_load_dwordx4 v5, s[4:7], s38 offen offset:3072 lds
  v_mfma_f32_32x32x16_bf16 v[56:71], v[124:127], v[196:199], v[56:71]
  ds_read_b64_tr_b16 v[112:113], v16 offset:64
  ds_read_b64_tr_b16 v[114:115], v16 offset:832
  s_and_b32 s52, s32, 1
  s_lshl1_add_u32 s52, s46, s52
  s_lshl_b32 s52, s52, 7
  s_add_u32 s52, s52, 6160384
  v_mfma_f32_32x32x16_bf16 v[72:87], v[128:131], v[196:199], v[72:87]
  ds_read_b64_tr_b16 v[116:117], v16 offset:128
  ds_read_b64_tr_b16 v[118:119], v16 offset:896
  s_cmp_eq_u32 s34, 15
  s_cselect_b32 s43, 5767168, s43
  s_cselect_b32 s52, 16777216, s52
  s_waitcnt vmcnt(11)
  s_barrier
  s_waitcnt lgkmcnt(6)
  v_mfma_f32_32x32x16_bf16 v[40:55], v[96:99], v[200:203], v[40:55]
  ds_read_b128 v[208:211], v9 offset:32768
  ds_read_b128 v[212:215], v10 offset:32768
  ds_read_b64_tr_b16 v[120:121], v13 offset:12288
  ds_read_b64_tr_b16 v[122:123], v13 offset:13056
  s_mul_i32 s45, s37, 176128
  s_add_u32 m0, s41, 36864
  s_add_u32 s45, s45, s36
  buffer_load_dwordx4 v6, s[8:11], s45 offen offset:0  lds
  s_add_u32 s37, s37, 1
  s_and_b32 s37, s37, 7
  v_mfma_f32_32x32x16_bf16 v[56:71], v[100:103], v[200:203], v[56:71]
  ds_read_b128 v[216:219], v11 offset:32768
  ds_read_b64_tr_b16 v[124:125], v13 offset:12352
  ds_read_b64_tr_b16 v[126:127], v13 offset:13120
  buffer_load_dwordx4 v7, s[8:11], s45 offen offset:1024  lds
  v_mfma_f32_32x32x16_bf16 v[72:87], v[104:107], v[200:203], v[72:87]
  ds_read_b128 v[220:223], v12 offset:32768
  ds_read_b64_tr_b16 v[128:129], v13 offset:12416
  ds_read_b64_tr_b16 v[130:131], v13 offset:13184
  buffer_load_dwordx4 v8, s[8:11], s45 offen offset:2048  lds
  s_waitcnt lgkmcnt(10)
  v_mfma_f32_32x32x16_bf16 v[40:55], v[108:111], v[204:207], v[40:55]
  ds_read_b64_tr_b16 v[96:97], v14 offset:12288
  ds_read_b64_tr_b16 v[98:99], v14 offset:13056
  v_mfma_f32_32x32x16_bf16 v[56:71], v[112:115], v[204:207], v[56:71]
  ds_read_b64_tr_b16 v[100:101], v14 offset:12352
  ds_read_b64_tr_b16 v[102:103], v14 offset:13120
  v_mfma_f32_32x32x16_bf16 v[72:87], v[116:119], v[204:207], v[72:87]
  ds_read_b64_tr_b16 v[104:105], v14 offset:12416
  ds_read_b64_tr_b16 v[106:107], v14 offset:13184
  s_waitcnt lgkmcnt(6)
  v_mfma_f32_32x32x16_bf16 v[40:55], v[120:123], v[208:211], v[40:55]
  ds_read_b64_tr_b16 v[108:109], v15 offset:12288
  ds_read_b64_tr_b16 v[110:111], v15 offset:13056
  v_mfma_f32_16x16x32_bf16 v[144:147], v[88:91], v[120:123], v[144:147]
  v_mfma_f32_32x32x16_bf16 v[56:71], v[124:127], v[208:211], v[56:71]
  ds_read_b64_tr_b16 v[112:113], v15 offset:12352
  ds_read_b64_tr_b16 v[114:115], v15 offset:13120
  v_mfma_f32_16x16x32_bf16 v[148:151], v[88:91], v[124:127], v[148:151]
  v_mfma_f32_32x32x16_bf16 v[72:87], v[128:131], v[208:211], v[72:87]
  ds_read_b64_tr_b16 v[116:117], v15 offset:12416
  ds_read_b64_tr_b16 v[118:119], v15 offset:13184
  v_mfma_f32_16x16x32_bf16 v[152:155], v[88:91], v[128:131], v[152:155]
  s_waitcnt lgkmcnt(6)
  v_mfma_f32_32x32x16_bf16 v[40:55], v[96:99], v[212:215], v[40:55]
  ds_read_b64_tr_b16 v[120:121], v16 offset:12288
  ds_read_b64_tr_b16 v[122:123], v16 offset:13056
  v_mfma_f32_32x32x16_bf16 v[56:71], v[100:103], v[212:215], v[56:71]
  ds_read_b64_tr_b16 v[124:125], v16 offset:12352
  ds_read_b64_tr_b16 v[126:127], v16 offset:13120
  v_mfma_f32_32x32x16_bf16 v[72:87], v[104:107], v[212:215], v[72:87]
  ds_read_b64_tr_b16 v[128:129], v16 offset:12416
  ds_read_b64_tr_b16 v[130:131], v16 offset:13184
  s_waitcnt vmcnt(7)
  s_barrier
  s_waitcnt lgkmcnt(6)
  v_mfma_f32_32x32x16_bf16 v[40:55], v[108:111], v[216:219], v[40:55]
  ds_read_b128 v[192:195], v9 offset:0
  ds_read_b128 v[196:199], v10 offset:0
  ds_read_b64_tr_b16 v[96:97], v13 offset:24576
  ds_read_b64_tr_b16 v[98:99], v13 offset:25344
  v_mfma_f32_32x32x16_bf16 v[56:71], v[112:115], v[216:219], v[56:71]
  ds_read_b128 v[200:203], v11 offset:0
  ds_read_b64_tr_b16 v[100:101], v13 offset:24640
  ds_read_b64_tr_b16 v[102:103], v13 offset:25408
  v_mfma_f32_32x32x16_bf16 v[72:87], v[116:119], v[216:219], v[72:87]
  ds_read_b128 v[204:207], v12 offset:0
  ds_read_b64_tr_b16 v[104:105], v13 offset:24704
  ds_read_b64_tr_b16 v[106:107], v13 offset:25472
  s_waitcnt lgkmcnt(10)
  v_mfma_f32_32x32x16_bf16 v[40:55], v[120:123], v[220:223], v[40:55]
  ds_read_b64_tr_b16 v[108:109], v14 offset:24576
  ds_read_b64_tr_b16 v[110:111], v14 offset:25344
  v_mov_b32 v168, 0
  v_mov_b32 v169, 0
  v_mov_b32 v170, 0
  v_mov_b32 v171, 0
  v_mfma_f32_32x32x16_bf16 v[56:71], v[124:127], v[220:223], v[56:71]
  ds_read_b64_tr_b16 v[112:113], v14 offset:24640
  ds_read_b64_tr_b16 v[114:115], v14 offset:25408
  v_mov_b32 v172, 0
  v_mov_b32 v173, 0
  v_mov_b32 v174, 0
  v_mov_b32 v175, 0
  v_mfma_f32_32x32x16_bf16 v[72:87], v[128:131], v[220:223], v[72:87]
  ds_read_b64_tr_b16 v[116:117], v14 offset:24704
  ds_read_b64_tr_b16 v[118:119], v14 offset:25472
  v_mov_b32 v176, 0
  v_mov_b32 v177, 0
  v_mov_b32 v178, 0
  v_mov_b32 v179, 0
  buffer_load_dwordx4 v[32:35], v31, s[12:15], s49 offen sc1
  s_waitcnt lgkmcnt(6)
  v_mfma_f32_32x32x16_bf16 v[40:55], v[96:99], v[192:195], v[40:55]
  ds_read_b64_tr_b16 v[120:121], v15 offset:24576
  ds_read_b64_tr_b16 v[122:123], v15 offset:25344
  v_mfma_f32_16x16x32_bf16 v[144:147], v[88:91], v[96:99], v[144:147]
  v_mfma_f32_32x32x16_bf16 v[56:71], v[100:103], v[192:195], v[56:71]
  ds_read_b64_tr_b16 v[124:125], v15 offset:24640
  ds_read_b64_tr_b16 v[126:127], v15 offset:25408
  v_mfma_f32_16x16x32_bf16 v[148:151], v[88:91], v[100:103], v[148:151]
  v_mfma_f32_32x32x16_bf16 v[72:87], v[104:107], v[192:195], v[72:87]
  ds_read_b64_tr_b16 v[128:129], v15 offset:24704
  ds_read_b64_tr_b16 v[130:131], v15 offset:25472
  v_mfma_f32_16x16x32_bf16 v[152:155], v[88:91], v[104:107], v[152:155]
  s_waitcnt lgkmcnt(6)
  v_mfma_f32_32x32x16_bf16 v[40:55], v[108:111], v[196:199], v[40:55]
  ds_read_b64_tr_b16 v[96:97], v16 offset:24576
  ds_read_b64_tr_b16 v[98:99], v16 offset:25344
  v_cvt_pk_bf16_f32 v145, v144, v144
  v_lshlrev_b32 v145, 16, v145
  v_sub_f32 v145, v144, v145
  v_cvt_pk_bf16_f32 v26, v144, v145
  ds_write2st64_b32 v29, v26, v26 offset0:0 offset1:12
  ds_write2st64_b32 v29, v26, v26 offset0:24 offset1:36
  v_mfma_f32_32x32x16_bf16 v[56:71], v[112:115], v[196:199], v[56:71]
  ds_read_b64_tr_b16 v[100:101], v16 offset:24640
  ds_read_b64_tr_b16 v[102:103], v16 offset:25408
  v_cvt_pk_bf16_f32 v149, v148, v148
  v_lshlrev_b32 v149, 16, v149
  v_sub_f32 v149, v148, v149
  v_cvt_pk_bf16_f32 v27, v148, v149
  ds_write2st64_b32 v29, v27, v27 offset0:4 offset1:16
  ds_write2st64_b32 v29, v27, v27 offset0:28 offset1:40
  v_mfma_f32_32x32x16_bf16 v[72:87], v[116:119], v[196:199], v[72:87]
  ds_read_b64_tr_b16 v[104:105], v16 offset:24704
  ds_read_b64_tr_b16 v[106:107], v16 offset:25472
  v_cvt_pk_bf16_f32 v153, v152, v152
  v_lshlrev_b32 v153, 16, v153
  v_sub_f32 v153, v152, v153
  v_cvt_pk_bf16_f32 v28, v152, v153
  ds_write2st64_b32 v29, v28, v28 offset0:8 offset1:20
  ds_write2st64_b32 v29, v28, v28 offset0:32 offset1:44
  s_waitcnt vmcnt(1)
  s_barrier
  s_waitcnt lgkmcnt(12)
  v_mfma_f32_32x32x16_bf16 v[40:55], v[120:123], v[200:203], v[40:55]
  ds_read_b128 v[208:211], v9 offset:16384
  ds_read_b128 v[212:215], v10 offset:16384
  ds_read_b64_tr_b16 v[108:109], v13 offset:36864
  ds_read_b64_tr_b16 v[110:111], v13 offset:37632
  v_mfma_f32_32x32x16_bf16 v[56:71], v[124:127], v[200:203], v[56:71]
  ds_read_b128 v[216:219], v11 offset:16384
  ds_read_b64_tr_b16 v[112:113], v13 offset:36928
  ds_read_b64_tr_b16 v[114:115], v13 offset:37696
  v_mfma_f32_32x32x16_bf16 v[72:87], v[128:131], v[200:203], v[72:87]
  ds_read_b128 v[220:223], v12 offset:16384
  ds_read_b64_tr_b16 v[116:117], v13 offset:36992
  ds_read_b64_tr_b16 v[118:119], v13 offset:37760
  s_waitcnt lgkmcnt(12)
  v_mfma_f32_32x32x16_bf16 v[40:55], v[96:99], v[204:207], v[40:55]
  ds_read_b64_tr_b16 v[120:121], v14 offset:36864
  ds_read_b64_tr_b16 v[122:123], v14 offset:37632
  v_mfma_f32_32x32x16_bf16 v[56:71], v[100:103], v[204:207], v[56:71]
  ds_read_b64_tr_b16 v[124:125], v14 offset:36928
  ds_read_b64_tr_b16 v[126:127], v14 offset:37696
  v_mfma_f32_32x32x16_bf16 v[72:87], v[104:107], v[204:207], v[72:87]
  ds_read_b64_tr_b16 v[128:129], v14 offset:36992
  ds_read_b64_tr_b16 v[130:131], v14 offset:37760
  s_waitcnt lgkmcnt(6)
  s_barrier
  v_mfma_f32_32x32x16_bf16 v[40:55], v[108:111], v[208:211], v[40:55]
  ds_read_b64_tr_b16 v[96:97], v15 offset:36864
  ds_read_b64_tr_b16 v[98:99], v15 offset:37632
  v_mfma_f32_16x16x32_bf16 v[156:159], v[88:91], v[108:111], 0
  s_mov_b32 exec_hi, 0
  ds_read2st64_b32 v[168:169], v23 offset0:0 offset1:1
  ds_read2st64_b32 v[170:171], v23 offset0:2 offset1:3
  s_mov_b32 exec_hi, -1
  v_mfma_f32_32x32x16_bf16 v[56:71], v[112:115], v[208:211], v[56:71]
  ds_read_b64_tr_b16 v[100:101], v15 offset:36928
  ds_read_b64_tr_b16 v[102:103], v15 offset:37696
  v_mfma_f32_16x16x32_bf16 v[160:163], v[88:91], v[112:115], 0
  s_mov_b32 exec_hi, 0
  ds_read2st64_b32 v[172:173], v23 offset0:4 offset1:5
  ds_read2st64_b32 v[174:175], v23 offset0:6 offset1:7
  s_mov_b32 exec_hi, -1
  v_mfma_f32_32x32x16_bf16 v[72:87], v[116:119], v[208:211], v[72:87]
  ds_read_b64_tr_b16 v[104:105], v15 offset:36992
  ds_read_b64_tr_b16 v[106:107], v15 offset:37760
  v_mfma_f32_16x16x32_bf16 v[164:167], v[88:91], v[116:119], 0
  s_mov_b32 exec_hi, 0
  ds_read2st64_b32 v[176:177], v23 offset0:8 offset1:9
  ds_read2st64_b32 v[178:179], v23 offset0:10 offset1:11
  s_mov_b32 exec_hi, -1
  s_waitcnt lgkmcnt(12)
  v_mfma_f32_32x32x16_bf16 v[40:55], v[120:123], v[212:215], v[40:55]
  ds_read_b64_tr_b16 v[108:109], v16 offset:36864
  ds_read_b64_tr_b16 v[110:111], v16 offset:37632
  v_mfma_f32_16x16x32_bf16 v[156:159], v[88:91], v[120:123], v[156:159]
  v_mfma_f32_32x32x16_bf16 v[56:71], v[124:127], v[212:215], v[56:71]
  ds_read_b64_tr_b16 v[112:113], v16 offset:36928
  ds_read_b64_tr_b16 v[114:115], v16 offset:37696
  v_mfma_f32_16x16x32_bf16 v[160:163], v[88:91], v[124:127], v[160:163]
  v_mfma_f32_32x32x16_bf16 v[72:87], v[128:131], v[212:215], v[72:87]
  ds_read_b64_tr_b16 v[116:117], v16 offset:36992
  ds_read_b64_tr_b16 v[118:119], v16 offset:37760
  v_mfma_f32_16x16x32_bf16 v[164:167], v[88:91], v[128:131], v[164:167]
  s_waitcnt vmcnt(0) lgkmcnt(6)
  s_mov_b32 s48, 0
G_stchk:
  v_cmp_ne_u64 vcc, s[50:51], v[34:35]
  s_cbranch_vccnz G_stslow
G_stok:
  v_mfma_f32_32x32x16_bf16 v[40:55], v[96:99], v[216:219], v[40:55]
  v_mfma_f32_16x16x32_bf16 v[156:159], v[88:91], v[96:99], v[156:159]
  v_mov_b32 v36, v32
  v_mov_b32 v37, v32
  v_mov_b32 v38, v32
  v_mov_b32 v39, v32
  v_mfma_f32_32x32x16_bf16 v[56:71], v[100:103], v[216:219], v[56:71]
  v_mfma_f32_16x16x32_bf16 v[160:163], v[88:91], v[100:103], v[160:163]
  v_mul_f32 v30, s47, v33
  v_mov_b32 v24, s50
  v_mov_b32 v25, s51
  v_mfma_f32_32x32x16_bf16 v[72:87], v[104:107], v[216:219], v[72:87]
  v_mfma_f32_16x16x32_bf16 v[164:167], v[88:91], v[104:107], v[164:167]
  s_waitcnt lgkmcnt(0)
  s_barrier
  v_mfma_f32_16x16x32_bf16 v[156:159], v[88:91], v[108:111], v[156:159]
  v_mfma_f32_16x16x32_bf16 v[160:163], v[88:91], v[112:115], v[160:163]
  v_mfma_f32_16x16x32_bf16 v[164:167], v[88:91], v[116:119], v[164:167]
  v_mfma_f32_32x32x16_bf16 v[40:55], v[108:111], v[220:223], v[40:55]
  s_nop 4
  v_cvt_pk_bf16_f32 v157, v156, v156
  v_lshlrev_b32 v157, 16, v157
  v_sub_f32 v157, v156, v157
  s_mov_b32 exec_lo, 0
  v_cvt_pk_bf16_f32 v168, v156, v157
  s_mov_b32 exec_lo, -1
  v_mfma_f32_32x32x16_bf16 v[56:71], v[112:115], v[220:223], v[56:71]
  v_cvt_pk_bf16_f32 v161, v160, v160
  v_lshlrev_b32 v161, 16, v161
  v_sub_f32 v161, v160, v161
  s_mov_b32 exec_lo, 0
  v_cvt_pk_bf16_f32 v172, v160, v161
  s_mov_b32 exec_lo, -1
  v_mfma_f32_32x32x16_bf16 v[72:87], v[116:119], v[220:223], v[72:87]
  v_cvt_pk_bf16_f32 v165, v164, v164
  v_lshlrev_b32 v165, 16, v165
  v_sub_f32 v165, v164, v165
  s_mov_b32 exec_lo, 0
  v_cvt_pk_bf16_f32 v176, v164, v165
  s_mov_b32 exec_lo, -1
  v_mfma_f32_32x32x16_bf16 v[40:55], v[168:171], v[36:39], v[40:55]
  v_mfma_f32_32x32x16_bf16 v[56:71], v[172:175], v[36:39], v[56:71]
  v_mfma_f32_32x32x16_bf16 v[72:87], v[176:179], v[36:39], v[72:87]
  s_nop 9
  v_mul_f32 v40, v30, v40
  v_mul_f32 v41, v30, v41
  v_mul_f32 v42, v30, v42
  v_mul_f32 v43, v30, v43
  v_mul_f32 v44, v30, v44
  v_mul_f32 v45, v30, v45
  v_mul_f32 v46, v30, v46
  v_mul_f32 v47, v30, v47
  v_exp_f32_e64 v208, -v40
  v_exp_f32_e64 v209, -v41
  v_exp_f32_e64 v210, -v42
  v_exp_f32_e64 v211, -v43
  v_exp_f32_e64 v212, -v44
  v_exp_f32_e64 v213, -v45
  v_exp_f32_e64 v214, -v46
  v_exp_f32_e64 v215, -v47
  v_fma_f32 v208, v208, s47, s47
  v_fma_f32 v209, v209, s47, s47
  v_fma_f32 v210, v210, s47, s47
  v_fma_f32 v211, v211, s47, s47
  v_fma_f32 v212, v212, s47, s47
  v_fma_f32 v213, v213, s47, s47
  v_fma_f32 v214, v214, s47, s47
  v_fma_f32 v215, v215, s47, s47
  v_rcp_f32 v208, v208
  v_rcp_f32 v209, v209
  v_rcp_f32 v210, v210
  v_rcp_f32 v211, v211
  v_rcp_f32 v212, v212
  v_rcp_f32 v213, v213
  v_rcp_f32 v214, v214
  v_rcp_f32 v215, v215
  v_mul_f32 v40, v40, v208
  v_mul_f32 v41, v41, v209
  v_mul_f32 v42, v42, v210
  v_mul_f32 v43, v43, v211
  v_mul_f32 v44, v44, v212
  v_mul_f32 v45, v45, v213
  v_mul_f32 v46, v46, v214
  v_mul_f32 v47, v47, v215
  v_cvt_pk_bf16_f32 v224, v40, v41
  v_cvt_pk_bf16_f32 v225, v42, v43
  v_cvt_pk_bf16_f32 v226, v44, v45
  v_cvt_pk_bf16_f32 v227, v46, v47
  buffer_store_dwordx4 v[224:227], v22, s[28:31], s43 offen offset:0 sc1
  v_mul_f32 v48, v30, v48
  v_mul_f32 v49, v30, v49
  v_mul_f32 v50, v30, v50
  v_mul_f32 v51, v30, v51
  v_mul_f32 v52, v30, v52
  v_mul_f32 v53, v30, v53
  v_mul_f32 v54, v30, v54
  v_mul_f32 v55, v30, v55
  v_exp_f32_e64 v216, -v48
  v_exp_f32_e64 v217, -v49
  v_exp_f32_e64 v218, -v50
  v_exp_f32_e64 v219, -v51
  v_exp_f32_e64 v220, -v52
  v_exp_f32_e64 v221, -v53
  v_exp_f32_e64 v222, -v54
  v_exp_f32_e64 v223, -v55
  v_fma_f32 v216, v216, s47, s47
  v_fma_f32 v217, v217, s47, s47
  v_fma_f32 v218, v218, s47, s47
  v_fma_f32 v219, v219, s47, s47
  v_fma_f32 v220, v220, s47, s47
  v_fma_f32 v221, v221, s47, s47
  v_fma_f32 v222, v222, s47, s47
  v_fma_f32 v223, v223, s47, s47
  v_rcp_f32 v216, v216
  v_rcp_f32 v217, v217
  v_rcp_f32 v218, v218
  v_rcp_f32 v219, v219
  v_rcp_f32 v220, v220
  v_rcp_f32 v221, v221
  v_rcp_f32 v222, v222
  v_rcp_f32 v223, v223
  v_mul_f32 v48, v48, v216
  v_mul_f32 v49, v49, v217
  v_mul_f32 v50, v50, v218
  v_mul_f32 v51, v51, v219
  v_mul_f32 v52, v52, v220
  v_mul_f32 v53, v53, v221
  v_mul_f32 v54, v54, v222
  v_mul_f32 v55, v55, v223
  v_cvt_pk_bf16_f32 v228, v48, v49
  v_cvt_pk_bf16_f32 v229, v50, v51
  v_cvt_pk_bf16_f32 v230, v52, v53
  v_cvt_pk_bf16_f32 v231, v54, v55
  buffer_store_dwordx4 v[228:231], v22, s[28:31], s43 offen offset:1024 sc1
  v_mul_f32 v56, v30, v56
  v_mul_f32 v57, v30, v57
  v_mul_f32 v58, v30, v58
  v_mul_f32 v59, v30, v59
  v_mul_f32 v60, v30, v60
  v_mul_f32 v61, v30, v61
  v_mul_f32 v62, v30, v62
  v_mul_f32 v63, v30, v63
  v_exp_f32_e64 v208, -v56
  v_exp_f32_e64 v209, -v57
  v_exp_f32_e64 v210, -v58
  v_exp_f32_e64 v211, -v59
  v_exp_f32_e64 v212, -v60
  v_exp_f32_e64 v213, -v61
  v_exp_f32_e64 v214, -v62
  v_exp_f32_e64 v215, -v63
  v_fma_f32 v208, v208, s47, s47
  v_fma_f32 v209, v209, s47, s47
  v_fma_f32 v210, v210, s47, s47
  v_fma_f32 v211, v211, s47, s47
  v_fma_f32 v212, v212, s47, s47
  v_fma_f32 v213, v213, s47, s47
  v_fma_f32 v214, v214, s47, s47
  v_fma_f32 v215, v215, s47, s47
  v_rcp_f32 v208, v208
  v_rcp_f32 v209, v209
  v_rcp_f32 v210, v210
  v_rcp_f32 v211, v211
  v_rcp_f32 v212, v212
  v_rcp_f32 v213, v213
  v_rcp_f32 v214, v214
  v_rcp_f32 v215, v215
  v_mul_f32 v56, v56, v208
  v_mul_f32 v57, v57, v209
  v_mul_f32 v58, v58, v210
  v_mul_f32 v59, v59, v211
  v_mul_f32 v60, v60, v212
  v_mul_f32 v61, v61, v213
  v_mul_f32 v62, v62, v214
  v_mul_f32 v63, v63, v215
  v_cvt_pk_bf16_f32 v232, v56, v57
  v_cvt_pk_bf16_f32 v233, v58, v59
  v_cvt_pk_bf16_f32 v234, v60, v61
  v_cvt_pk_bf16_f32 v235, v62, v63
  buffer_store_dwordx4 v[232:235], v22, s[28:31], s43 offen offset:2048 sc1
  v_mul_f32 v64, v30, v64
  v_mul_f32 v65, v30, v65
  v_mul_f32 v66, v30, v66
  v_mul_f32 v67, v30, v67
  v_mul_f32 v68, v30, v68
  v_mul_f32 v69, v30, v69
  v_mul_f32 v70, v30, v70
  v_mul_f32 v71, v30, v71
  v_exp_f32_e64 v216, -v64
  v_exp_f32_e64 v217, -v65
  v_exp_f32_e64 v218, -v66
  v_exp_f32_e64 v219, -v67
  v_exp_f32_e64 v220, -v68
  v_exp_f32_e64 v221, -v69
  v_exp_f32_e64 v222, -v70
  v_exp_f32_e64 v223, -v71
  v_fma_f32 v216, v216, s47, s47
  v_fma_f32 v217, v217, s47, s47
  v_fma_f32 v218, v218, s47, s47
  v_fma_f32 v219, v219, s47, s47
  v_fma_f32 v220, v220, s47, s47
  v_fma_f32 v221, v221, s47, s47
  v_fma_f32 v222, v222, s47, s47
  v_fma_f32 v223, v223, s47, s47
  v_rcp_f32 v216, v216
  v_rcp_f32 v217, v217
  v_rcp_f32 v218, v218
  v_rcp_f32 v219, v219
  v_rcp_f32 v220, v220
  v_rcp_f32 v221, v221
  v_rcp_f32 v222, v222
  v_rcp_f32 v223, v223
  v_mul_f32 v64, v64, v216
  v_mul_f32 v65, v65, v217
  v_mul_f32 v66, v66, v218
  v_mul_f32 v67, v67, v219
  v_mul_f32 v68, v68, v220
  v_mul_f32 v69, v69, v221
  v_mul_f32 v70, v70, v222
  v_mul_f32 v71, v71, v223
  v_cvt_pk_bf16_f32 v236, v64, v65
  v_cvt_pk_bf16_f32 v237, v66, v67
  v_cvt_pk_bf16_f32 v238, v68, v69
  v_cvt_pk_bf16_f32 v239, v70, v71
  buffer_store_dwordx4 v[236:239], v22, s[28:31], s43 offen offset:3072 sc1
  v_mul_f32 v72, v30, v72
  v_mul_f32 v73, v30, v73
  v_mul_f32 v74, v30, v74
  v_mul_f32 v75, v30, v75
  v_mul_f32 v76, v30, v76
  v_mul_f32 v77, v30, v77
  v_mul_f32 v78, v30, v78
  v_mul_f32 v79, v30, v79
  v_exp_f32_e64 v208, -v72
  v_exp_f32_e64 v209, -v73
  v_exp_f32_e64 v210, -v74
  v_exp_f32_e64 v211, -v75
  v_exp_f32_e64 v212, -v76
  v_exp_f32_e64 v213, -v77
  v_exp_f32_e64 v214, -v78
  v_exp_f32_e64 v215, -v79
  v_fma_f32 v208, v208, s47, s47
  v_fma_f32 v209, v209, s47, s47
  v_fma_f32 v210, v210, s47, s47
  v_fma_f32 v211, v211, s47, s47
  v_fma_f32 v212, v212, s47, s47
  v_fma_f32 v213, v213, s47, s47
  v_fma_f32 v214, v214, s47, s47
  v_fma_f32 v215, v215, s47, s47
  v_rcp_f32 v208, v208
  v_rcp_f32 v209, v209
  v_rcp_f32 v210, v210
  v_rcp_f32 v211, v211
  v_rcp_f32 v212, v212
  v_rcp_f32 v213, v213
  v_rcp_f32 v214, v214
  v_rcp_f32 v215, v215
  v_mul_f32 v72, v72, v208
  v_mul_f32 v73, v73, v209
  v_mul_f32 v74, v74, v210
  v_mul_f32 v75, v75, v211
  v_mul_f32 v76, v76, v212
  v_mul_f32 v77, v77, v213
  v_mul_f32 v78, v78, v214
  v_mul_f32 v79, v79, v215
  v_cvt_pk_bf16_f32 v240, v72, v73
  v_cvt_pk_bf16_f32 v241, v74, v75
  v_cvt_pk_bf16_f32 v242, v76, v77
  v_cvt_pk_bf16_f32 v243, v78, v79
  buffer_store_dwordx4 v[240:243], v22, s[28:31], s59 offen offset:0 sc1
  v_mul_f32 v80, v30, v80
  v_mul_f32 v81, v30, v81
  v_mul_f32 v82, v30, v82
  v_mul_f32 v83, v30, v83
  v_mul_f32 v84, v30, v84
  v_mul_f32 v85, v30, v85
  v_mul_f32 v86, v30, v86
  v_mul_f32 v87, v30, v87
  v_exp_f32_e64 v216, -v80
  v_exp_f32_e64 v217, -v81
  v_exp_f32_e64 v218, -v82
  v_exp_f32_e64 v219, -v83
  v_exp_f32_e64 v220, -v84
  v_exp_f32_e64 v221, -v85
  v_exp_f32_e64 v222, -v86
  v_exp_f32_e64 v223, -v87
  v_fma_f32 v216, v216, s47, s47
  v_fma_f32 v217, v217, s47, s47
  v_fma_f32 v218, v218, s47, s47
  v_fma_f32 v219, v219, s47, s47
  v_fma_f32 v220, v220, s47, s47
  v_fma_f32 v221, v221, s47, s47
  v_fma_f32 v222, v222, s47, s47
  v_fma_f32 v223, v223, s47, s47
  v_rcp_f32 v216, v216
  v_rcp_f32 v217, v217
  v_rcp_f32 v218, v218
  v_rcp_f32 v219, v219
  v_rcp_f32 v220, v220
  v_rcp_f32 v221, v221
  v_rcp_f32 v222, v222
  v_rcp_f32 v223, v223
  v_mul_f32 v80, v80, v216
  v_mul_f32 v81, v81, v217
  v_mul_f32 v82, v82, v218
  v_mul_f32 v83, v83, v219
  v_mul_f32 v84, v84, v220
  v_mul_f32 v85, v85, v221
  v_mul_f32 v86, v86, v222
  v_mul_f32 v87, v87, v223
  v_cvt_pk_bf16_f32 v244, v80, v81
  v_cvt_pk_bf16_f32 v245, v82, v83
  v_cvt_pk_bf16_f32 v246, v84, v85
  v_cvt_pk_bf16_f32 v247, v86, v87
  buffer_store_dwordx4 v[244:247], v22, s[28:31], s59 offen offset:1024 sc1
  s_lshl_b32 s39, s32, 3
  s_lshr_b32 s45, 0x160e0600, s39
  s_and_b32 s45, s45, 0xff
  s_lshr_b32 s39, 0x1d150f07, s39
  s_and_b32 s39, s39, 0xff
  v_max_u32 v4, s45, v1
  v_min_u32 v4, s39, v4
  v_lshlrev_b32 v4, 7, v4
  s_and_b32 s39, s32, 1
  s_mul_i32 s45, s39, 90112
  v_add_u32 v2, s45, v22
  s_sub_u32 s45, 90112, s45
  v_add_u32 v3, s45, v22
  s_mov_b32 s48, 0
  s_movk_i32 s37, 144
  s_lshl_b32 s58, s53, 12
  s_add_u32 s58, s58, 6160384
  s_barrier
  ds_read_b64_tr_b16 v[112:113], v18 offset:0
  ds_read_b64_tr_b16 v[114:115], v18 offset:1024
  ds_read_b64_tr_b16 v[116:117], v19 offset:0
  ds_read_b64_tr_b16 v[118:119], v19 offset:1024
  ds_read_b64_tr_b16 v[120:121], v18 offset:2048
  ds_read_b64_tr_b16 v[122:123], v18 offset:3072
  ds_read_b64_tr_b16 v[124:125], v19 offset:2048
  ds_read_b64_tr_b16 v[126:127], v19 offset:3072
  ds_read_b64_tr_b16 v[128:129], v20 offset:12288
  ds_read_b64_tr_b16 v[130:131], v20 offset:13312
  ds_read_b64_tr_b16 v[132:133], v21 offset:12288
  ds_read_b64_tr_b16 v[134:135], v21 offset:13312
  ds_read_b64_tr_b16 v[136:137], v20 offset:14336
  ds_read_b64_tr_b16 v[138:139], v18 offset:16384
  ds_read_b64_tr_b16 v[140:141], v21 offset:14336
  ds_read_b64_tr_b16 v[142:143], v19 offset:16384
  ds_read_b64_tr_b16 v[144:145], v18 offset:17408
  ds_read_b64_tr_b16 v[146:147], v18 offset:18432
  ds_read_b64_tr_b16 v[148:149], v19 offset:17408
  ds_read_b64_tr_b16 v[150:151], v19 offset:18432
  ds_read_b64_tr_b16 v[152:153], v18 offset:19456
  ds_read_b64_tr_b16 v[154:155], v20 offset:0
  ds_read_b64_tr_b16 v[156:157], v19 offset:19456
  ds_read_b64_tr_b16 v[158:159], v21 offset:0
  ds_read_b64_tr_b16 v[160:161], v20 offset:1024
  ds_read_b64_tr_b16 v[162:163], v20 offset:2048
  ds_read_b64_tr_b16 v[164:165], v21 offset:1024
  ds_read_b64_tr_b16 v[166:167], v21 offset:2048
  ds_read_b64_tr_b16 v[168:169], v20 offset:24576
  ds_read_b64_tr_b16 v[170:171], v20 offset:25600
  ds_read_b64_tr_b16 v[172:173], v21 offset:24576
  ds_read_b64_tr_b16 v[174:175], v21 offset:25600
  ds_read_b64_tr_b16 v[176:177], v20 offset:26624
  ds_read_b64_tr_b16 v[178:179], v20 offset:36864
  ds_read_b64_tr_b16 v[180:181], v21 offset:26624
  ds_read_b64_tr_b16 v[182:183], v21 offset:36864
  ds_read_b64_tr_b16 v[184:185], v20 offset:37888
  ds_read_b64_tr_b16 v[186:187], v20 offset:38912
  ds_read_b64_tr_b16 v[188:189], v21 offset:37888
  ds_read_b64_tr_b16 v[190:191], v21 offset:38912
  ds_read_b64_tr_b16 v[96:97], v18 offset:32768
  ds_read_b64_tr_b16 v[98:99], v18 offset:33792
  ds_read_b64_tr_b16 v[100:101], v19 offset:32768
  ds_read_b64_tr_b16 v[102:103], v19 offset:33792
  ds_read_b64_tr_b16 v[104:105], v18 offset:34816
  ds_read_b64_tr_b16 v[106:107], v18 offset:35840
  ds_read_b64_tr_b16 v[108:109], v19 offset:34816
  ds_read_b64_tr_b16 v[110:111], v19 offset:35840
  s_waitcnt vmcnt(0)
  s_mov_b64 exec, 1
  buffer_store_dwordx2 v[24:25], off, s[12:15], s52 sc1
G_pub:
  s_mov_b64 exec, -1
  s_waitcnt lgkmcnt(15)
  s_add_u32 m0, s40, 0
  s_add_u32 s46, s42, 196608
  buffer_load_dwordx4 v17, s[16:19], s46 offen lds
  s_add_u32 m0, s40, 1024
  s_add_u32 s46, s42, 204800
  buffer_load_dwordx4 v17, s[16:19], s46 offen lds
  s_add_u32 m0, s40, 2048
  s_add_u32 s46, s42, 212992
  buffer_load_dwordx4 v17, s[16:19], s46 offen lds
  s_add_u32 m0, s40, 3072
  s_add_u32 s46, s42, 221184
  buffer_load_dwordx4 v17, s[16:19], s46 offen lds
  s_add_u32 m0, s41, 12288
  s_add_u32 s46, s42, 229376
  buffer_load_dwordx4 v17, s[16:19], s46 offen lds
  s_add_u32 m0, s41, 13312
  s_add_u32 s46, s42, 237568
  buffer_load_dwordx4 v17, s[16:19], s46 offen lds
  s_add_u32 m0, s41, 14336
  s_add_u32 s46, s42, 245760
  buffer_load_dwordx4 v17, s[16:19], s46 offen lds
  s_add_u32 m0, s40, 16384
  s_add_u32 s46, s42, 253952
  buffer_load_dwordx4 v17, s[16:19], s46 offen lds
  s_add_u32 m0, s40, 17408
  s_add_u32 s46, s42, 262144
  buffer_load_dwordx4 v17, s[16:19], s46 offen lds
  s_add_u32 m0, s40, 18432
  s_add_u32 s46, s42, 270336
  buffer_load_dwordx4 v17, s[16:19], s46 offen lds
  s_add_u32 m0, s40, 19456
  s_add_u32 s46, s42, 278528
  buffer_load_dwordx4 v17, s[16:19], s46 offen lds
  s_add_u32 m0, s41, 0
  s_add_u32 s46, s42, 286720
  buffer_load_dwordx4 v17, s[16:19], s46 offen lds
  s_add_u32 m0, s41, 1024
  s_add_u32 s46, s42, 294912
  buffer_load_dwordx4 v17, s[16:19], s46 offen lds
  s_add_u32 m0, s41, 2048
  s_add_u32 s46, s42, 303104
  buffer_load_dwordx4 v17, s[16:19], s46 offen lds
  s_add_u32 m0, s41, 24576
  s_add_u32 s46, s42, 311296
  buffer_load_dwordx4 v17, s[16:19], s46 offen lds
  s_add_u32 m0, s41, 25600
  s_add_u32 s46, s42, 319488
  buffer_load_dwordx4 v17, s[16:19], s46 offen lds
  s_waitcnt lgkmcnt(12)
  s_add_u32 m0, s41, 26624
  s_add_u32 s46, s42, 327680
  buffer_load_dwordx4 v17, s[16:19], s46 offen lds
  s_add_u32 m0, s41, 36864
  s_add_u32 s46, s42, 335872
  buffer_load_dwordx4 v17, s[16:19], s46 offen lds
  buffer_load_dwordx2 v[10:11], v4, s[12:15], s58 offen sc1
  s_waitcnt lgkmcnt(8)
  s_add_u32 m0, s41, 37888
  s_add_u32 s46, s42, 344064
  buffer_load_dwordx4 v17, s[16:19], s46 offen lds
  s_add_u32 m0, s41, 38912
  s_add_u32 s46, s42, 352256
  buffer_load_dwordx4 v17, s[16:19], s46 offen lds
  s_waitcnt vmcnt(2)
G_hchk:
  v_cmp_ne_u64 vcc, s[50:51], v[10:11]
  s_add_u32 s48, s48, 1
  s_cbranch_vccnz G_hslow
G_hok:
  s_add_u32 s38, s44, 0
  buffer_load_dwordx4 v[192:195], v3, s[28:31], s38 offen offset:0 sc1
  buffer_load_dwordx4 v[196:199], v3, s[28:31], s38 offen offset:1024 sc1
  buffer_load_dwordx4 v[200:203], v3, s[28:31], s38 offen offset:2048 sc1
  buffer_load_dwordx4 v[204:207], v3, s[28:31], s38 offen offset:3072 sc1
  s_add_u32 s38, s44, 4096
  buffer_load_dwordx4 v[208:211], v3, s[28:31], s38 offen offset:0 sc1
  buffer_load_dwordx4 v[212:215], v3, s[28:31], s38 offen offset:1024 sc1
  buffer_load_dwordx4 v[216:219], v3, s[28:31], s38 offen offset:2048 sc1
  buffer_load_dwordx4 v[220:223], v3, s[28:31], s38 offen offset:3072 sc1
  s_add_u32 s38, s44, 8192
  buffer_load_dwordx4 v[224:227], v3, s[28:31], s38 offen offset:0 sc1
  s_lshl1_add_u32 s45, s53, s39
  s_lshr_b32 s39, s32, 1
  s_lshl1_add_u32 s48, s56, s39
  s_lshl_b32 s49, s45, 15
  s_lshl_b32 s39, s48, 6
  s_add_u32 s49, s49, s39
  s_add_u32 s43, s45, 8
  s_bfe_u32 s43, s43, 0x10004
  s_lshl_b32 s39, s48, 6
  s_add_u32 s43, s43, s39
  s_lshl_b32 s43, s43, 7
  s_add_u32 s43, s43, 6029312
  s_mul_i32 s52, s48, 147456
  s_lshl_b32 s39, s45, 6
  s_add_u32 s52, s52, s39
  s_add_u32 s52, s52, 11010048
  v_and_b32 v23, 31, v1
  v_lshrrev_b32 v29, 5, v1
  v_lshlrev_b32 v6, 10, v23
  v_lshl_add_u32 v6, v29, 4, v6
  v_lshl_add_u32 v8, v23, 6, s40
  v_lshl_add_u32 v8, v29, 4, v8
  v_lshlrev_b32 v9, 3, v29
  v_sub_u32 v4, v23, v9
  v_bfe_u32 v23, v1, 2, 2
  v_add_u32 v9, v9, v23
  v_lshl_add_u32 v9, v9, 6, s40
  v_bfe_u32 v23, v1, 4, 1
  v_lshl_add_u32 v9, v23, 5, v9
  v_and_b32 v23, 3, v1
  v_lshl_add_u32 v9, v23, 3, v9
  v_lshrrev_b32 v7, 2, v1
  v_mul_u32_u24 v7, 4608, v7
  v_lshl_add_u32 v7, v23, 4, v7
  v_lshrrev_b32 v5, 2, v1
  v_lshlrev_b32 v5, 10, v5
  v_and_b32 v23, 3, v1
  v_lshl_add_u32 v5, v23, 4, v5
  v_add_u32 v13, s41, v22
  s_xor_b32 s39, s32, 1
  s_mulk_i32 s39, 3072
  s_add_u32 s39, s39, 49152
  v_add_u32 v14, s39, v22
  s_xor_b32 s39, s32, 2
  s_mulk_i32 s39, 3072
  s_add_u32 s39, s39, 49152
  v_add_u32 v15, s39, v22
  s_xor_b32 s39, s32, 3
  s_mulk_i32 s39, 3072
  s_add_u32 s39, s39, 49152
  v_add_u32 v16, s39, v22
  v_and_b32 v23, 1, v4
  v_lshlrev_b32 v23, 4, v23
  v_mov_b32 v11, 0x3f80
  v_lshlrev_b32 v11, v23, v11
  v_ashrrev_i32 v4, 1, v4
  v_cmp_eq_u32 s[88:89], 0, v4
  v_cmp_eq_u32 s[90:91], 1, v4
  s_nop 0
  v_cndmask_b32 v24, 0, v11, s[88:89]
  v_cmp_eq_u32 s[88:89], 2, v4
  v_cndmask_b32 v25, 0, v11, s[90:91]
  v_cmp_eq_u32 s[90:91], 3, v4
  v_cndmask_b32 v26, 0, v11, s[88:89]
  v_cmp_eq_u32 s[88:89], 8, v4
  v_cndmask_b32 v27, 0, v11, s[90:91]
  v_cmp_eq_u32 s[90:91], 9, v4
  v_cndmask_b32 v28, 0, v11, s[88:89]
  v_cmp_eq_u32 s[88:89], 10, v4
  v_cndmask_b32 v29, 0, v11, s[90:91]
  v_cmp_eq_u32 s[90:91], 11, v4
  v_cndmask_b32 v30, 0, v11, s[88:89]
  s_nop 0
  v_cndmask_b32 v31, 0, v11, s[90:91]
  s_waitcnt vmcnt(8) lgkmcnt(0)
  v_mfma_f32_32x32x16_bf16 v[48:63], v[96:99], v[192:195], 0
  buffer_load_dwordx4 v[228:231], v3, s[28:31], s38 offen offset:1024 sc1
  v_mfma_f32_32x32x16_bf16 v[80:95], v[100:103], v[192:195], 0
  s_waitcnt vmcnt(8)
  v_mfma_f32_32x32x16_bf16 v[48:63], v[104:107], v[196:199], v[48:63]
  buffer_load_dwordx4 v[192:195], v3, s[28:31], s38 offen offset:2048 sc1
  v_mfma_f32_32x32x16_bf16 v[80:95], v[108:111], v[196:199], v[80:95]
  s_waitcnt vmcnt(8)
  v_mfma_f32_32x32x16_bf16 v[48:63], v[112:115], v[200:203], v[48:63]
  buffer_load_dwordx4 v[196:199], v3, s[28:31], s38 offen offset:3072 sc1
  v_mfma_f32_32x32x16_bf16 v[80:95], v[116:119], v[200:203], v[80:95]
  s_waitcnt vmcnt(8)
  v_mfma_f32_32x32x16_bf16 v[48:63], v[120:123], v[204:207], v[48:63]
  s_add_u32 s38, s44, 12288
  buffer_load_dwordx4 v[200:203], v3, s[28:31], s38 offen offset:0 sc1
  v_mfma_f32_32x32x16_bf16 v[80:95], v[124:127], v[204:207], v[80:95]
  s_waitcnt vmcnt(8)
  v_mfma_f32_32x32x16_bf16 v[48:63], v[128:131], v[208:211], v[48:63]
  buffer_load_dwordx4 v[204:207], v2, s[28:31], s38 offen offset:0 sc1
  v_mfma_f32_32x32x16_bf16 v[80:95], v[132:135], v[208:211], v[80:95]
  s_waitcnt vmcnt(8)
  v_mfma_f32_32x32x16_bf16 v[48:63], v[136:139], v[212:215], v[48:63]
  buffer_load_dwordx4 v[208:211], v3, s[28:31], s38 offen offset:1024 sc1
  v_mfma_f32_32x32x16_bf16 v[80:95], v[140:143], v[212:215], v[80:95]
  v_and_b32 v12, 31, v1
  v_lshlrev_b32 v12, 8, v12
  s_waitcnt vmcnt(8)
  v_mfma_f32_32x32x16_bf16 v[48:63], v[144:147], v[216:219], v[48:63]
  buffer_load_dwordx4 v[212:215], v2, s[28:31], s38 offen offset:1024 sc1
  v_mfma_f32_32x32x16_bf16 v[80:95], v[148:151], v[216:219], v[80:95]
  s_waitcnt vmcnt(8)
  v_mfma_f32_32x32x16_bf16 v[48:63], v[152:155], v[220:223], v[48:63]
  buffer_load_dwordx4 v[216:219], v3, s[28:31], s38 offen offset:2048 sc1
  v_mfma_f32_32x32x16_bf16 v[80:95], v[156:159], v[220:223], v[80:95]
  s_waitcnt vmcnt(8)
  v_mfma_f32_32x32x16_bf16 v[48:63], v[160:163], v[224:227], v[48:63]
  buffer_load_dwordx4 v[220:223], v2, s[28:31], s38 offen offset:2048 sc1
  ds_read_b64_tr_b16 v[232:233], v18 offset:0
  ds_read_b64_tr_b16 v[234:235], v18 offset:1024
  v_mfma_f32_32x32x16_bf16 v[80:95], v[164:167], v[224:227], v[80:95]
  ds_read_b64_tr_b16 v[236:237], v19 offset:0
  ds_read_b64_tr_b16 v[238:239], v19 offset:1024
  s_waitcnt vmcnt(8)
  v_mfma_f32_32x32x16_bf16 v[48:63], v[168:171], v[228:231], v[48:63]
  buffer_load_dwordx4 v[224:227], v3, s[28:31], s38 offen offset:3072 sc1
  v_mfma_f32_32x32x16_bf16 v[80:95], v[172:175], v[228:231], v[80:95]
  s_waitcnt vmcnt(8)
  v_mfma_f32_32x32x16_bf16 v[48:63], v[176:179], v[192:195], v[48:63]
  buffer_load_dwordx4 v[228:231], v2, s[28:31], s38 offen offset:3072 sc1
  ds_read_b64_tr_b16 v[240:241], v18 offset:2048
  ds_read_b64_tr_b16 v[242:243], v18 offset:3072
  v_mfma_f32_32x32x16_bf16 v[80:95], v[180:183], v[192:195], v[80:95]
  ds_read_b64_tr_b16 v[244:245], v19 offset:2048
  ds_read_b64_tr_b16 v[246:247], v19 offset:3072
  s_waitcnt vmcnt(8)
  v_mfma_f32_32x32x16_bf16 v[48:63], v[184:187], v[196:199], v[48:63]
  s_add_u32 s38, s44, 16384
  buffer_load_dwordx4 v[192:195], v3, s[28:31], s38 offen offset:0 sc1
  v_mfma_f32_32x32x16_bf16 v[80:95], v[188:191], v[196:199], v[80:95]
  s_waitcnt vmcnt(8) lgkmcnt(4)
  v_mfma_f32_32x32x16_bf16 v[48:63], v[232:235], v[200:203], v[48:63]
  buffer_load_dwordx4 v[196:199], v2, s[28:31], s38 offen offset:0 sc1
  ds_read_b64_tr_b16 v[248:249], v20 offset:12288
  ds_read_b64_tr_b16 v[250:251], v20 offset:13312
  v_mfma_f32_32x32x16_bf16 v[80:95], v[236:239], v[200:203], v[80:95]
  ds_read_b64_tr_b16 v[252:253], v21 offset:12288
  ds_read_b64_tr_b16 v[254:255], v21 offset:13312
  s_waitcnt vmcnt(8)
  v_mfma_f32_32x32x16_bf16 v[32:47], v[232:235], v[204:207], 0
  buffer_load_dwordx4 v[200:203], v3, s[28:31], s38 offen offset:1024 sc1
  v_mfma_f32_32x32x16_bf16 v[64:79], v[236:239], v[204:207], 0
  s_waitcnt vmcnt(8) lgkmcnt(4)
  v_mfma_f32_32x32x16_bf16 v[48:63], v[240:243], v[208:211], v[48:63]
  buffer_load_dwordx4 v[204:207], v2, s[28:31], s38 offen offset:1024 sc1
  ds_read_b64_tr_b16 v[232:233], v20 offset:14336
  ds_read_b64_tr_b16 v[234:235], v18 offset:16384
  v_mfma_f32_32x32x16_bf16 v[80:95], v[244:247], v[208:211], v[80:95]
  ds_read_b64_tr_b16 v[236:237], v21 offset:14336
  ds_read_b64_tr_b16 v[238:239], v19 offset:16384
  s_waitcnt vmcnt(8)
  v_mfma_f32_32x32x16_bf16 v[32:47], v[240:243], v[212:215], v[32:47]
  buffer_load_dwordx4 v[208:211], v3, s[28:31], s38 offen offset:2048 sc1
  v_mfma_f32_32x32x16_bf16 v[64:79], v[244:247], v[212:215], v[64:79]
  s_waitcnt vmcnt(8) lgkmcnt(4)
  v_mfma_f32_32x32x16_bf16 v[48:63], v[248:251], v[216:219], v[48:63]
  buffer_load_dwordx4 v[212:215], v2, s[28:31], s38 offen offset:2048 sc1
  ds_read_b64_tr_b16 v[240:241], v18 offset:17408
  ds_read_b64_tr_b16 v[242:243], v18 offset:18432
  v_mfma_f32_32x32x16_bf16 v[80:95], v[252:255], v[216:219], v[80:95]
  ds_read_b64_tr_b16 v[244:245], v19 offset:17408
  ds_read_b64_tr_b16 v[246:247], v19 offset:18432
  s_waitcnt vmcnt(8)
  v_mfma_f32_32x32x16_bf16 v[32:47], v[248:251], v[220:223], v[32:47]
  buffer_load_dwordx4 v[216:219], v3, s[28:31], s38 offen offset:3072 sc1
  v_mfma_f32_32x32x16_bf16 v[64:79], v[252:255], v[220:223], v[64:79]
  s_waitcnt vmcnt(8) lgkmcnt(4)
  v_mfma_f32_32x32x16_bf16 v[48:63], v[232:235], v[224:227], v[48:63]
  buffer_load_dwordx4 v[220:223], v2, s[28:31], s38 offen offset:3072 sc1
  ds_read_b64_tr_b16 v[248:249], v18 offset:19456
  ds_read_b64_tr_b16 v[250:251], v20 offset:0
  v_mfma_f32_32x32x16_bf16 v[80:95], v[236:239], v[224:227], v[80:95]
  ds_read_b64_tr_b16 v[252:253], v19 offset:19456
  ds_read_b64_tr_b16 v[254:255], v21 offset:0
  s_waitcnt vmcnt(8)
  v_mfma_f32_32x32x16_bf16 v[32:47], v[232:235], v[228:231], v[32:47]
  s_add_u32 s38, s44, 20480
  buffer_load_dwordx4 v[224:227], v3, s[28:31], s38 offen offset:0 sc1
  v_mfma_f32_32x32x16_bf16 v[64:79], v[236:239], v[228:231], v[64:79]
  s_waitcnt vmcnt(8) lgkmcnt(4)
  v_mfma_f32_32x32x16_bf16 v[48:63], v[240:243], v[192:195], v[48:63]
  buffer_load_dwordx4 v[228:231], v2, s[28:31], s38 offen offset:0 sc1
  ds_read_b64_tr_b16 v[232:233], v20 offset:1024
  ds_read_b64_tr_b16 v[234:235], v20 offset:2048
  v_mfma_f32_32x32x16_bf16 v[80:95], v[244:247], v[192:195], v[80:95]
  ds_read_b64_tr_b16 v[236:237], v21 offset:1024
  ds_read_b64_tr_b16 v[238:239], v21 offset:2048
  s_waitcnt vmcnt(8)
  v_mfma_f32_32x32x16_bf16 v[32:47], v[240:243], v[196:199], v[32:47]
  buffer_load_dwordx4 v[192:195], v3, s[28:31], s38 offen offset:1024 sc1
  v_mfma_f32_32x32x16_bf16 v[64:79], v[244:247], v[196:199], v[64:79]
  s_waitcnt vmcnt(8) lgkmcnt(4)
  v_mfma_f32_32x32x16_bf16 v[48:63], v[248:251], v[200:203], v[48:63]
  buffer_load_dwordx4 v[196:199], v2, s[28:31], s38 offen offset:1024 sc1
  ds_read_b64_tr_b16 v[240:241], v20 offset:24576
  ds_read_b64_tr_b16 v[242:243], v20 offset:25600
  v_mfma_f32_32x32x16_bf16 v[80:95], v[252:255], v[200:203], v[80:95]
  ds_read_b64_tr_b16 v[244:245], v21 offset:24576
  ds_read_b64_tr_b16 v[246:247], v21 offset:25600
  s_waitcnt vmcnt(8)
  v_mfma_f32_32x32x16_bf16 v[32:47], v[248:251], v[204:207], v[32:47]
  s_add_u32 s38, s44, 0
  buffer_load_dwordx4 v[200:203], v2, s[28:31], s38 offen offset:0 sc1
  v_mfma_f32_32x32x16_bf16 v[64:79], v[252:255], v[204:207], v[64:79]
  s_waitcnt vmcnt(8) lgkmcnt(4)
  v_mfma_f32_32x32x16_bf16 v[48:63], v[232:235], v[208:211], v[48:63]
  buffer_load_dwordx4 v[204:207], v2, s[28:31], s38 offen offset:1024 sc1
  ds_read_b64_tr_b16 v[248:249], v20 offset:26624
  ds_read_b64_tr_b16 v[250:251], v20 offset:36864
  v_mfma_f32_32x32x16_bf16 v[80:95], v[236:239], v[208:211], v[80:95]
  ds_read_b64_tr_b16 v[252:253], v21 offset:26624
  ds_read_b64_tr_b16 v[254:255], v21 offset:36864
  s_waitcnt vmcnt(8)
  v_mfma_f32_32x32x16_bf16 v[32:47], v[232:235], v[212:215], v[32:47]
  buffer_load_dwordx4 v[208:211], v2, s[28:31], s38 offen offset:2048 sc1
  v_mfma_f32_32x32x16_bf16 v[64:79], v[236:239], v[212:215], v[64:79]
  s_waitcnt vmcnt(8) lgkmcnt(4)
  v_mfma_f32_32x32x16_bf16 v[48:63], v[240:243], v[216:219], v[48:63]
  buffer_load_dwordx4 v[212:215], v2, s[28:31], s38 offen offset:3072 sc1
  ds_read_b64_tr_b16 v[232:233], v20 offset:37888
  ds_read_b64_tr_b16 v[234:235], v20 offset:38912
  v_mfma_f32_32x32x16_bf16 v[80:95], v[244:247], v[216:219], v[80:95]
  ds_read_b64_tr_b16 v[236:237], v21 offset:37888
  ds_read_b64_tr_b16 v[238:239], v21 offset:38912
  s_waitcnt vmcnt(8)
  v_mfma_f32_32x32x16_bf16 v[32:47], v[240:243], v[220:223], v[32:47]
  s_add_u32 s38, s44, 4096
  buffer_load_dwordx4 v[216:219], v2, s[28:31], s38 offen offset:0 sc1
  v_mfma_f32_32x32x16_bf16 v[64:79], v[244:247], v[220:223], v[64:79]
  s_waitcnt vmcnt(8) lgkmcnt(4)
  v_mfma_f32_32x32x16_bf16 v[48:63], v[248:251], v[224:227], v[48:63]
  buffer_load_dwordx4 v[220:223], v2, s[28:31], s38 offen offset:1024 sc1
  v_mfma_f32_32x32x16_bf16 v[80:95], v[252:255], v[224:227], v[80:95]
  s_waitcnt vmcnt(8)
  v_mfma_f32_32x32x16_bf16 v[32:47], v[248:251], v[228:231], v[32:47]
  buffer_load_dwordx4 v[224:227], v2, s[28:31], s38 offen offset:2048 sc1
  v_mfma_f32_32x32x16_bf16 v[64:79], v[252:255], v[228:231], v[64:79]
  s_waitcnt vmcnt(8) lgkmcnt(0)
  v_mfma_f32_32x32x16_bf16 v[48:63], v[232:235], v[192:195], v[48:63]
  buffer_load_dwordx4 v[228:231], v2, s[28:31], s38 offen offset:3072 sc1
  v_mfma_f32_32x32x16_bf16 v[80:95], v[236:239], v[192:195], v[80:95]
  buffer_load_dwordx2 v[10:11], v12, s[12:15], s43 offen sc1
  s_mov_b32 m0, s40
  s_add_u32 s45, s49, 15360
  buffer_load_dwordx4 v5, s[4:7], s49 offen lds
  buffer_load_dwordx4 v5, s[4:7], s45 offen offset:1024 lds
  s_waitcnt vmcnt(11)
  v_mfma_f32_32x32x16_bf16 v[32:47], v[232:235], v[196:199], v[32:47]
  s_add_u32 s38, s44, 8192
  buffer_load_dwordx4 v[192:195], v2, s[28:31], s38 offen offset:0 sc1
  v_mfma_f32_32x32x16_bf16 v[64:79], v[236:239], v[196:199], v[64:79]
  s_waitcnt vmcnt(11)
  v_mfma_f32_32x32x16_bf16 v[32:47], v[96:99], v[200:203], v[32:47]
  buffer_load_dwordx4 v[196:199], v2, s[28:31], s38 offen offset:1024 sc1
  ds_write_b128 v13, v[48:51] offset:0
  v_mfma_f32_32x32x16_bf16 v[64:79], v[100:103], v[200:203], v[64:79]
  ds_write_b128 v13, v[52:55] offset:1024
  s_waitcnt vmcnt(11)
  v_mfma_f32_32x32x16_bf16 v[32:47], v[104:107], v[204:207], v[32:47]
  buffer_load_dwordx4 v[200:203], v2, s[28:31], s38 offen offset:2048 sc1
  v_mfma_f32_32x32x16_bf16 v[64:79], v[108:111], v[204:207], v[64:79]
  ds_write_b128 v13, v[56:59] offset:2048
  s_waitcnt vmcnt(11)
  v_mfma_f32_32x32x16_bf16 v[32:47], v[112:115], v[208:211], v[32:47]
  buffer_load_dwordx4 v[204:207], v2, s[28:31], s38 offen offset:3072 sc1
  ds_write_b128 v13, v[60:63] offset:12288
  v_mfma_f32_32x32x16_bf16 v[64:79], v[116:119], v[208:211], v[64:79]
  s_waitcnt vmcnt(11)
  v_mfma_f32_32x32x16_bf16 v[32:47], v[120:123], v[212:215], v[32:47]
  ds_write_b128 v13, v[80:83] offset:26624
  v_mfma_f32_32x32x16_bf16 v[64:79], v[124:127], v[212:215], v[64:79]
  ds_write_b128 v13, v[84:87] offset:36864
  s_waitcnt vmcnt(10)
  v_mfma_f32_32x32x16_bf16 v[32:47], v[128:131], v[216:219], v[32:47]
  s_and_b32 s39, s32, 1
  s_mulk_i32 s39, 4608
  s_lshr_b32 s45, s32, 1
  s_lshl_b32 s45, s45, 6
  s_add_u32 s39, s39, s45
  s_add_u32 s39, s39, 98304
  v_and_b32 v23, 31, v1
  v_mul_u32_u24 v2, 144, v23
  v_mfma_f32_32x32x16_bf16 v[64:79], v[132:135], v[216:219], v[64:79]
  ds_write_b128 v13, v[88:91] offset:37888
  s_waitcnt vmcnt(9)
  v_mfma_f32_32x32x16_bf16 v[32:47], v[136:139], v[220:223], v[32:47]
  ds_write_b128 v13, v[92:95] offset:38912
  v_mfma_f32_32x32x16_bf16 v[64:79], v[140:143], v[220:223], v[64:79]
  s_waitcnt vmcnt(6)
  v_cmp_ne_u64 s[94:95], s[50:51], v[10:11]
  s_add_u32 m0, s40, 32768
  s_add_u32 s45, s52, 0
  buffer_load_dwordx4 v7, s[12:15], s45 offen offset:0 sc1 lds
  s_add_u32 s45, s52, 72704
  buffer_load_dwordx4 v7, s[12:15], s45 offen offset:1024 sc1 lds
  v_lshrrev_b32 v23, 5, v1
  v_lshl_add_u32 v2, v23, 4, v2
  v_add_u32 v2, s39, v2
  v_lshrrev_b32 v23, 3, v1
  v_and_b32 v4, 7, v1
  v_lshlrev_b32 v4, 4, v4
  v_mad_u32_u24 v3, v23, s37, v4
  v_lshl_add_u32 v4, v23, 10, v4
  v_mfma_f32_32x32x16_bf16 v[32:47], v[144:147], v[224:227], v[32:47]
  s_waitcnt vmcnt(6)
  ds_read_b128 v[248:251], v8 offset:0
  ds_read_b128 v[252:255], v8 offset:32
  v_mfma_f32_32x32x16_bf16 v[64:79], v[148:151], v[224:227], v[64:79]
  s_mul_i32 s39, s32, 2304
  s_add_u32 s39, s39, 98304
  v_add_u32 v3, s39, v3
  s_lshl2_add_u32 s35, s53, s32
  s_lshl_b32 s35, s35, 14
  s_lshl_b32 s39, s56, 7
  s_add_u32 s35, s35, s39
  s_add_u32 s36, s35, 8192
  v_mfma_f32_32x32x16_bf16 v[32:47], v[152:155], v[228:231], v[32:47]
  s_waitcnt lgkmcnt(2)
  s_barrier
  ds_read_b128 v[48:51], v14 offset:0
  ds_read_b128 v[52:55], v14 offset:1024
  ds_read_b128 v[56:59], v14 offset:2048
  ds_read_b128 v[60:63], v14 offset:12288
  v_mfma_f32_32x32x16_bf16 v[64:79], v[156:159], v[228:231], v[64:79]
  ds_read_b128 v[80:83], v16 offset:26624
  ds_read_b128 v[84:87], v16 offset:36864
  ds_read_b128 v[88:91], v16 offset:37888
  ds_read_b128 v[92:95], v16 offset:38912
  s_waitcnt vmcnt(5)
  v_mfma_f32_32x32x16_bf16 v[64:79], v[164:167], v[192:195], v[64:79]
  s_waitcnt vmcnt(4)
  v_mfma_f32_32x32x16_bf16 v[64:79], v[172:175], v[196:199], v[64:79]
  s_waitcnt vmcnt(3)
  v_mfma_f32_32x32x16_bf16 v[64:79], v[180:183], v[200:203], v[64:79]
  s_waitcnt lgkmcnt(0)
  v_add_f32 v48, v48, v80
  v_add_f32 v49, v49, v81
  v_add_f32 v50, v50, v82
  v_add_f32 v51, v51, v83
  v_add_f32 v52, v52, v84
  s_waitcnt vmcnt(2)
  v_mfma_f32_32x32x16_bf16 v[64:79], v[188:191], v[204:207], v[64:79]
  v_add_f32 v53, v53, v85
  v_add_f32 v54, v54, v86
  v_add_f32 v55, v55, v87
  v_add_f32 v56, v56, v88
  v_add_f32 v57, v57, v89
  v_add_f32 v58, v58, v90
  v_mfma_f32_32x32x16_bf16 v[32:47], v[160:163], v[192:195], v[32:47]
  v_add_f32 v59, v59, v91
  v_add_f32 v60, v60, v92
  v_add_f32 v61, v61, v93
  v_add_f32 v62, v62, v94
  v_add_f32 v63, v63, v95
  v_mfma_f32_32x32x16_bf16 v[32:47], v[168:171], v[196:199], v[32:47]
  ds_write_b128 v13, v[64:67] offset:13312
  v_mfma_f32_32x32x16_bf16 v[32:47], v[176:179], v[200:203], v[32:47]
  ds_write_b128 v13, v[68:71] offset:14336
  v_mfma_f32_32x32x16_bf16 v[32:47], v[184:187], v[204:207], v[32:47]
  ds_write_b128 v13, v[72:75] offset:24576
  v_mfma_f32_32x32x16_bf16 v[32:47], v[24:27], v[248:251], v[32:47]
  ds_write_b128 v13, v[76:79] offset:25600
  s_cmp_lg_u64 s[94:95], 0
  s_cbranch_scc1 G_yslow
G_yok:
  s_waitcnt vmcnt(0)
  ds_read_b64_tr_b16 v[240:241], v9 offset:32768
  ds_read_b64_tr_b16 v[242:243], v9 offset:33024
  ds_read_b64_tr_b16 v[244:245], v9 offset:33792
  ds_read_b64_tr_b16 v[246:247], v9 offset:34048
  v_mfma_f32_32x32x16_bf16 v[32:47], v[28:31], v[252:255], v[32:47]
  s_waitcnt lgkmcnt(4)
  s_barrier
  ds_read_b128 v[64:67], v15 offset:13312
  ds_read_b128 v[68:71], v15 offset:14336
  ds_read_b128 v[72:75], v15 offset:24576
  ds_read_b128 v[76:79], v15 offset:25600
  s_waitcnt lgkmcnt(4)
  v_mfma_f32_32x32x16_bf16 v[32:47], v[24:27], v[240:243], v[32:47]
  v_mfma_f32_32x32x16_bf16 v[32:47], v[28:31], v[244:247], v[32:47]
  s_waitcnt lgkmcnt(0)
  v_add_f32 v48, v48, v64
  v_add_f32 v49, v49, v65
  v_add_f32 v50, v50, v66
  v_add_f32 v51, v51, v67
  v_add_f32 v52, v52, v68
  v_add_f32 v53, v53, v69
  v_add_f32 v54, v54, v70
  v_add_f32 v55, v55, v71
  v_add_f32 v56, v56, v72
  v_add_f32 v57, v57, v73
  v_add_f32 v58, v58, v74
  v_add_f32 v59, v59, v75
  v_add_f32 v60, v60, v76
  v_add_f32 v61, v61, v77
  v_add_f32 v62, v62, v78
  v_add_f32 v63, v63, v79
  v_pk_add_f32 v[32:33], v[32:33], v[48:49]
  v_pk_add_f32 v[34:35], v[34:35], v[50:51]
  v_pk_add_f32 v[36:37], v[36:37], v[52:53]
  v_pk_add_f32 v[38:39], v[38:39], v[54:55]
  v_pk_add_f32 v[40:41], v[40:41], v[56:57]
  v_pk_add_f32 v[42:43], v[42:43], v[58:59]
  v_pk_add_f32 v[44:45], v[44:45], v[60:61]
  v_pk_add_f32 v[46:47], v[46:47], v[62:63]
  v_cvt_pk_bf16_f32 v24, v32, v33
  v_cvt_pk_bf16_f32 v25, v34, v35
  v_cvt_pk_bf16_f32 v26, v36, v37
  v_cvt_pk_bf16_f32 v27, v38, v39
  v_cvt_pk_bf16_f32 v28, v40, v41
  v_cvt_pk_bf16_f32 v29, v42, v43
  v_cvt_pk_bf16_f32 v30, v44, v45
  v_cvt_pk_bf16_f32 v31, v46, v47
  v_permlane32_swap_b32 v24, v26
  v_permlane32_swap_b32 v25, v27
  ds_write_b128 v2, v[24:27] offset:0
  v_permlane32_swap_b32 v28, v30
  v_permlane32_swap_b32 v29, v31
  ds_write_b128 v2, v[28:31] offset:32
  s_waitcnt lgkmcnt(0)
  s_barrier
  ds_read_b128 v[32:35], v3 offset:0
  ds_read_b128 v[36:39], v3 offset:1152
  s_waitcnt lgkmcnt(1)
  buffer_store_dwordx4 v[32:35], v4, s[20:23], s35 offen sc1
  s_waitcnt lgkmcnt(0)
  buffer_store_dwordx4 v[36:39], v4, s[20:23], s36 offen sc1
  s_endpgm
G_tagslow:
  s_load_dwordx2 s[50:51], s[24:25], 64
  s_waitcnt lgkmcnt(0)
  s_cmp_lg_u32 s50, 0
  s_cbranch_scc1 G_tagok
  s_load_dwordx2 s[50:51], s[24:25], 192
  s_waitcnt lgkmcnt(0)
  s_cmp_lg_u32 s50, 0
  s_cbranch_scc1 G_tagok
  s_mov_b32 s48, 0
G_tagloop:
  buffer_load_dwordx2 v[24:25], off, s[24:27], 0 sc1
  s_add_u32 s48, s48, 1
  s_waitcnt vmcnt(0)
  v_readfirstlane_b32 s50, v24
  v_readfirstlane_b32 s51, v25
  s_nop 3
  s_cmp_lg_u32 s50, 0
  s_cbranch_scc1 G_tagok
  s_cmp_lt_u32 s48, 100000
  s_cbranch_scc1 G_tagloop
  s_branch G_tagok
G_stslow:
  s_add_u32 s48, s48, 1
  s_cmp_ge_u32 s48, 100000
  s_cbranch_scc1 G_stok
  buffer_load_dwordx4 v[32:35], v31, s[12:15], s49 offen sc1
  s_waitcnt vmcnt(0)
  s_branch G_stchk
G_hslow:
  s_cmp_ge_u32 s48, 100000
  s_cbranch_scc1 G_hok
  buffer_load_dwordx2 v[10:11], v4, s[12:15], s58 offen sc1
  s_waitcnt vmcnt(0)
  s_branch G_hchk
G_yslow:
  s_mov_b32 s48, 0
G_yloop:
  buffer_load_dwordx2 v[10:11], v12, s[12:15], s43 offen sc1
  s_add_u32 s48, s48, 1
  s_waitcnt vmcnt(0)
  v_cmp_ne_u64 vcc, s[50:51], v[10:11]
  s_cmp_lt_u32 s48, 100000
  s_cselect_b64 vcc, vcc, 0
  s_cbranch_vccnz G_yloop
  s_add_u32 m0, s40, 32768
  s_add_u32 s45, s52, 0
  buffer_load_dwordx4 v7, s[12:15], s45 offen offset:0 sc1 lds
  s_add_u32 s45, s52, 72704
  buffer_load_dwordx4 v7, s[12:15], s45 offen offset:1024 sc1 lds
  s_waitcnt vmcnt(0)
  s_branch G_yok
.p2align 6
L_ssm:
  s_mov_b32 s18, 2097152
  s_mov_b32 s19, 0x20000
  s_mov_b32 s90, 1409024
  s_mov_b32 s91, 0x20000
  v_lshrrev_b32 v54, 3, v1
  v_lshlrev_b32 v54, 10, v54
  v_lshrrev_b32 v55, 4, v1
  v_xor_b32 v55, v55, v1
  v_and_b32 v55, 7, v55
  v_lshl_add_u32 v2, v55, 4, v54
  v_xor_b32 v3, 64, v2
  v_add_u32 v4, 14336, v2
  v_add_u32 v5, 21504, v3
  v_add_u32 v3, 7168, v3
  s_movk_i32 s26, 5462
  s_movk_i32 s27, 2560
  v_mul_u32_u24 v54, s26, v1
  v_lshrrev_b32 v55, 16, v54
  v_mad_u32_u24 v6, v55, s27, v60
  v_add_u32 v54, 349568, v54
  v_lshrrev_b32 v55, 16, v54
  v_mad_u32_u24 v7, v55, s27, v60
  v_add_u32 v54, 349568, v54
  v_lshrrev_b32 v55, 16, v54
  v_mad_u32_u24 v8, v55, s27, v60
  s_bfe_u32 s22, s2, 0x20001
  s_bfe_u32 s24, s2, 0x20003
  s_lshl2_add_u32 s22, s22, s24
  s_lshl2_add_u32 s22, s22, s32
  s_lshl_b32 s22, s22, 15
  s_and_b32 s24, s2, 1
  s_bfe_u32 s25, s2, 0x30005
  s_lshl3_add_u32 s24, s24, s25
  s_mul_i32 s23, s24, 192
  s_mul_i32 s26, s32, 44032
  s_add_u32 s23, s23, s26
  s_cmp_eq_u32 s24, 15
  s_cselect_b32 s22, 1073741824, s22
  s_cselect_b32 s23, 1073741824, s23
  s_and_b32 s25, s2, 6
  s_add_u32 s24, s24, s25
  s_add_u32 s25, s24, 1
  s_and_b32 s25, s25, 7
  s_add_u32 s24, s24, 2
  s_and_b32 s24, s24, 7
  s_lshl_b32 s20, s32, 12
  s_mul_i32 s21, s32, 3072
  s_add_u32 s21, s21, 49152
  s_mov_b32 s14, 16777216
  s_mov_b32 s15, 0x20000
  s_lshr_b32 s5, s32, 1
  s_and_b32 s6, s32, 1
  s_mov_b32 s41, 0xffff0000
  s_mul_i32 s34, s5, 4576
  s_add_u32 s34, s34, 131584
  v_lshl_add_u32 v54, v1, 3, s34
  v_mov_b32 v56, 0
  v_mov_b32 v57, 0
  ds_write_b64 v54, v[56:57]
  s_lshl2_add_u32 s34, s32, 140752
  v_mov_b32 v58, s34
  ds_write_b32 v58, v56
  ds_write_b32 v58, v56 offset:16
  s_lshl_b32 s34, s32, 12
  s_add_u32 s34, s34, 147456
  v_add_u32 v61, s34, v60
  v_lshrrev_b32 v54, 4, v1
  v_lshl_add_u32 v59, v54, 6, s34
  v_and_b32 v54, 15, v1
  v_lshlrev_b32 v51, 3, v54
  v_lshlrev_b32 v55, 2, v54
  v_add_u32 v55, 476, v55
  v_cmp_lt_u32 vcc, 8, v54
  v_add_u32 v56, 928, v51
  v_add_u32 v57, 1424, v51
  v_cndmask_b32 v50, v54, v55, vcc
  v_cmp_lt_u32 vcc, 11, v54
  v_cmp_lt_u32 s[56:57], 13, v54
  v_cvt_f32_u32 v51, v51
  v_cndmask_b32 v50, v50, v56, vcc
  v_cndmask_b32 v50, v50, v57, s[56:57]
  v_cvt_f32_u32 v50, v50
  s_waitcnt lgkmcnt(0)
  s_lshl_b32 s7, s42, 16
  s_and_b32 s34, s42, s41
  s_cmp_eq_u32 s5, 0
  s_cselect_b32 s7, s7, s34
  v_mov_b32 v54, 0x3fb8aa3b
  v_mul_f32 v54, s7, v54
  v_exp_f32 v54, v54
  s_waitcnt vmcnt(0)
  v_lshlrev_b32 v44, 16, v44
  v_lshlrev_b32 v45, 16, v45
  v_lshlrev_b32 v46, 16, v46
  v_lshlrev_b32 v47, 16, v47
  v_lshlrev_b32 v48, 16, v48
  v_lshlrev_b32 v49, 16, v49
  v_cvt_pk_bf16_f32 v54, v54, v54
  v_lshlrev_b32 v54, 16, v54
  v_mul_f32 v64, v44, v54
  v_mul_f32 v65, v45, v54
  v_mul_f32 v46, v46, v54
  v_mul_f32 v47, v47, v54
  v_mul_f32 v64, 0x3fb8aa3b, v64
  v_mul_f32 v65, 0.15915494, v65
  v_rndne_f32 v54, v65
  v_sub_f32 v65, v65, v54
  v_mul_f32 v66, v49, v47
  v_mul_f32 v67, v49, v46
  v_fma_f32 v66, v48, v46, -v66
  v_fmac_f32 v67, v48, v47
  v_mul_f32 v136, 0x43000000, v64
  v_mul_f32 v137, 0x43000000, v65
  v_mul_f32 v140, 0x43800000, v64
  v_mul_f32 v141, 0x43800000, v65
  v_fract_f32 v137, v137
  v_exp_f32 v136, v136
  v_fract_f32 v141, v141
  v_exp_f32 v140, v140
  v_cos_f32 v138, v137
  v_sin_f32 v139, v137
  v_cos_f32 v142, v141
  v_sin_f32 v143, v141
  ds_write_b128 v61, v[64:67]
  v_mul_f32 v138, v138, v136
  v_mul_f32 v139, v139, v136
  v_mul_f32 v70, v142, v140
  v_mul_f32_e64 v71, -v143, v140
  v_mul_f32 v68, v67, v139
  v_mul_f32 v69, v67, v138
  v_fma_f32 v68, v66, v138, -v68
  v_fmac_f32 v69, v66, v139
  ds_write_b128 v61, v[68:71] offset:1024
  ds_read_b128 v[72:75], v59 offset:0
  ds_read_b128 v[76:79], v59 offset:1024
  ds_read_b128 v[80:83], v59 offset:16
  ds_read_b128 v[84:87], v59 offset:1040
  ds_read_b128 v[88:91], v59 offset:32
  ds_read_b128 v[92:95], v59 offset:1056
  ds_read_b128 v[96:99], v59 offset:48
  ds_read_b128 v[100:103], v59 offset:1072
  v_lshrrev_b32 v56, 2, v1
  s_lshl_b32 s26, s25, 7
  s_add_u32 m0, s20, 16384
  s_add_u32 s26, s26, s22
  buffer_load_dwordx4 v2, s[16:19], s26 offen offset:0 lds
  s_add_u32 s25, s25, 1
  s_and_b32 s25, s25, 7
  v_bfe_u32 v57, v1, 1, 1
  v_and_b32 v55, 1, v1
  v_mul_u32_u24 v30, 18432, v56
  v_lshl_add_u32 v30, v57, 6, v30
  v_lshl_add_u32 v30, v55, 4, v30
  v_mul_u32_u24 v31, 4576, v55
  v_lshl_add_u32 v31, v56, 4, v31
  v_lshl_add_u32 v31, v57, 3, v31
  buffer_load_dwordx4 v3, s[16:19], s26 offen offset:1024 lds
  s_lshl_b32 s7, s32, 10
  s_add_u32 s7, s7, 132064
  v_add_u32 v31, s7, v31
  s_mul_i32 s54, s32, 1179648
  s_lshr_b32 s7, s3, 1
  s_lshl_b32 s7, s7, 7
  s_add_u32 s54, s54, s7
  s_and_b32 s7, s3, 1
  s_lshl_b32 s7, s7, 5
  s_add_u32 s54, s54, s7
  s_add_u32 s54, s54, 6291456
  s_mov_b32 s94, 1409024
  s_mov_b32 s95, 0x20000
  v_lshrrev_b32 v54, 3, v1
  buffer_load_dwordx4 v4, s[16:19], s26 offen offset:2048 lds
  v_lshlrev_b32 v54, 10, v54
  v_bfe_u32 v55, v1, 4, 1
  v_lshlrev_b32 v56, 2, v55
  v_xor_b32 v56, v56, v1
  v_and_b32 v56, 7, v56
  v_lshl_add_u32 v62, v56, 4, v54
  v_min_u32 v63, 23, v1
  v_lshrrev_b32 v54, 2, v63
  buffer_load_dwordx4 v5, s[16:19], s26 offen offset:3072 lds
  v_and_b32 v63, 3, v63
  v_lshlrev_b32 v63, 7, v63
  v_lshl_add_u32 v63, v54, 10, v63
  s_mul_i32 s28, s32, 360448
  s_and_b32 s29, s3, 31
  s_mul_i32 s30, s29, 5120
  s_mulk_i32 s29, 6144
  s_add_u32 s29, s29, s28
  s_add_u32 s30, s30, s28
  s_add_u32 s30, s30, 196608
  s_and_b32 s7, s2, 1
  s_lshl_b32 s34, s7, 9
  s_add_u32 s29, s29, s34
  s_add_u32 s30, s30, s34
  s_bfe_u32 s34, s2, 0x20006
  s_lshl2_add_u32 s7, s7, s34
  s_lshl_b32 s7, s7, 7
  s_add_u32 s28, s28, s7
  v_lshrrev_b32 v55, 4, v1
  s_mul_i32 s27, s24, 176128
  s_add_u32 m0, s21, 24576
  s_add_u32 s27, s27, s23
  buffer_load_dwordx4 v6, s[88:91], s27 offen offset:0 lds
  s_add_u32 s24, s24, 1
  s_and_b32 s24, s24, 7
  v_and_b32 v56, 15, v1
  s_lshl_b32 s34, s32, 12
  s_add_u32 s34, s34, 147456
  v_lshl_add_u32 v32, v56, 4, s34
  v_lshl_add_u32 v32, v55, 10, v32
  s_lshl_b32 s7, s5, 13
  s_add_u32 s7, s7, 147456
  v_add_u32 v33, s7, v60
  buffer_load_dwordx4 v7, s[88:91], s27 offen offset:1024 lds
  s_xor_b32 s34, s34, 4096
  v_add_u32 v40, s34, v60
  v_xor_b32 v27, 4, v58
  s_mul_i32 s7, s5, 4576
  s_add_u32 s7, s7, 131840
  s_lshl_b32 s34, s6, 8
  v_lshl_add_u32 v37, v56, 5, s7
  v_lshl_add_u32 v38, v55, 3, v37
  s_barrier
  s_setprio 0
  v_lshlrev_b32 v56, 4, v55
  buffer_load_dwordx4 v8, s[88:91], s27 offen offset:2048 lds
  v_add_u32 v37, v56, v37
  v_subrev_u32 v37, s34, v37
  v_bfe_u32 v55, v1, 2, 2
  v_sub_u32 v57, 0, v55
  v_and_b32 v57, 3, v57
  v_mul_u32_u24 v36, 4160, v57
  v_min_u32 v55, 1, v55
  v_lshlrev_b32 v55, 3, v55
  s_lshl_b32 s26, s25, 7
  s_add_u32 m0, s20, 32768
  s_add_u32 s26, s26, s22
  buffer_load_dwordx4 v2, s[16:19], s26 offen offset:0 lds
  s_add_u32 s25, s25, 1
  s_and_b32 s25, s25, 7
  v_sub_u32 v36, v36, v55
  v_sub_u32 v36, v36, v56
  v_and_b32 v55, 3, v1
  v_lshl_add_u32 v36, v55, 3, v36
  s_mul_i32 s7, s5, 16640
  s_add_u32 s7, s7, 98304
  v_mov_b32 v42, s7
  s_add_u32 s34, s34, s7
  s_add_u32 s34, s34, 56
  v_add_u32 v36, s34, v36
  buffer_load_dwordx4 v3, s[16:19], s26 offen offset:1024 lds
  s_lshl_b32 s34, s6, 11
  s_add_u32 s34, s34, s7
  s_add_u32 s34, s34, 32
  v_add_u32 v34, s34, v60
  v_and_b32 v55, 15, v1
  v_lshl_add_u32 v39, v55, 5, s34
  v_lshrrev_b32 v55, 4, v1
  v_lshl_add_u32 v39, v55, 3, v39
  buffer_load_dwordx4 v4, s[16:19], s26 offen offset:2048 lds
  v_bfe_u32 v35, v1, 3, 2
  v_mul_u32_u24 v35, 4160, v35
  v_and_b32 v57, 7, v1
  v_lshl_add_u32 v35, v57, 2, v35
  v_add_u32 v35, s7, v35
  s_lshl2_add_u32 s7, s5, 140736
  v_mov_b32 v41, s7
  v_and_b32 v57, 1, v1
  buffer_load_dwordx4 v5, s[16:19], s26 offen offset:3072 lds
  v_cmp_eq_u32 s[58:59], 1, v57
  v_cmp_le_u32 s[56:57], 32, v1
  ds_read_b128 v[104:107], v59 offset:256
  ds_read_b128 v[108:111], v59 offset:1280
  ds_read_b128 v[112:115], v59 offset:272
  ds_read_b128 v[116:119], v59 offset:1296
  ds_read_b128 v[120:123], v59 offset:288
  ds_read_b128 v[124:127], v59 offset:1312
  ds_read_b128 v[128:131], v59 offset:304
  ds_read_b128 v[132:135], v59 offset:1328
  s_waitcnt lgkmcnt(8)
  v_mul_f32 v136, v72, v50
  s_mul_i32 s27, s24, 176128
  s_add_u32 m0, s21, 36864
  s_add_u32 s27, s27, s23
  buffer_load_dwordx4 v6, s[88:91], s27 offen offset:0 lds
  s_add_u32 s24, s24, 1
  s_and_b32 s24, s24, 7
  v_mul_f32 v137, v73, v50
  buffer_load_dwordx4 v7, s[88:91], s27 offen offset:1024 lds
  buffer_load_dwordx4 v8, s[88:91], s27 offen offset:2048 lds
  s_waitcnt vmcnt(10)
  s_barrier
  v_mul_f32 v140, v72, v51
  v_mul_f32 v141, v73, v51
  v_mul_f32 v144, v80, v50
  v_mul_f32 v145, v81, v50
  v_mul_f32 v148, v80, v51
  v_mul_f32 v149, v81, v51
  v_fract_f32 v137, v137
  v_exp_f32 v136, v136
  v_exp_f32 v140, v140
  v_fract_f32 v145, v145
  v_exp_f32 v144, v144
  v_exp_f32 v148, v148
  v_cos_f32 v138, v137
  v_sin_f32 v139, v137
  v_cos_f32 v142, v141
  v_sin_f32 v143, v141
  v_cos_f32 v146, v145
  v_sin_f32 v147, v145
  v_cos_f32 v150, v149
  v_sin_f32 v151, v149
  v_mul_f32 v138, v138, v136
  v_mul_f32_e64 v139, -v139, v136
  v_mul_f32 v142, v142, v140
  v_mul_f32 v143, v143, v140
  v_mul_f32 v146, v146, v144
  v_mul_f32_e64 v147, -v147, v144
  v_mul_f32 v150, v150, v148
  v_mul_f32 v151, v151, v148
  v_cvt_pk_bf16_f32 v152, v138, v139
  v_mul_f32 v136, v139, v79
  v_mul_f32 v137, v139, v78
  v_fma_f32 v136, v138, v78, -v136
  v_fmac_f32 v137, v138, v79
  v_mul_f32 v140, v143, v75
  v_mul_f32 v141, v143, v74
  v_fma_f32 v140, v142, v74, -v140
  v_fmac_f32 v141, v142, v75
  v_cvt_pk_bf16_f32 v156, v136, v137
  v_mul_f32 v138, v143, v77
  v_mul_f32 v139, v143, v76
  v_fma_f32 v138, v142, v76, -v138
  v_fmac_f32 v139, v142, v77
  v_cvt_pk_bf16_f32 v160, v140, v141
  v_cvt_pk_bf16_f32 v164, v138, v139
  v_cvt_pk_bf16_f32 v153, v146, v147
  v_mul_f32 v144, v147, v87
  v_mul_f32 v145, v147, v86
  v_fma_f32 v144, v146, v86, -v144
  v_fmac_f32 v145, v146, v87
  v_mul_f32 v148, v151, v83
  v_mul_f32 v149, v151, v82
  v_fma_f32 v148, v150, v82, -v148
  v_fmac_f32 v149, v150, v83
  v_cvt_pk_bf16_f32 v157, v144, v145
  v_mul_f32 v146, v151, v85
  v_mul_f32 v147, v151, v84
  v_fma_f32 v146, v150, v84, -v146
  v_fmac_f32 v147, v150, v85
  v_cvt_pk_bf16_f32 v161, v148, v149
  v_cvt_pk_bf16_f32 v165, v146, v147
  v_mul_f32 v136, v88, v50
  v_mul_f32 v137, v89, v50
  v_mul_f32 v140, v88, v51
  v_mul_f32 v141, v89, v51
  v_mul_f32 v144, v96, v50
  v_mul_f32 v145, v97, v50
  v_mul_f32 v148, v96, v51
  v_mul_f32 v149, v97, v51
  v_fract_f32 v137, v137
  v_exp_f32 v136, v136
  v_exp_f32 v140, v140
  v_fract_f32 v145, v145
  v_exp_f32 v144, v144
  v_exp_f32 v148, v148
  v_cos_f32 v138, v137
  v_sin_f32 v139, v137
  v_cos_f32 v142, v141
  v_sin_f32 v143, v141
  v_cos_f32 v146, v145
  s_waitcnt vmcnt(3)
  s_barrier
  v_sin_f32 v147, v145
  v_cos_f32 v150, v149
  v_sin_f32 v151, v149
  v_mul_f32 v138, v138, v136
  v_mul_f32_e64 v139, -v139, v136
  v_mul_f32 v142, v142, v140
  v_mul_f32 v143, v143, v140
  v_mul_f32 v146, v146, v144
  v_mul_f32_e64 v147, -v147, v144
  v_mul_f32 v150, v150, v148
  v_mul_f32 v151, v151, v148
  v_cvt_pk_bf16_f32 v154, v138, v139
  v_mul_f32 v136, v139, v95
  v_mul_f32 v137, v139, v94
  v_fma_f32 v136, v138, v94, -v136
  v_fmac_f32 v137, v138, v95
  v_mul_f32 v140, v143, v91
  v_mul_f32 v141, v143, v90
  v_fma_f32 v140, v142, v90, -v140
  v_fmac_f32 v141, v142, v91
  v_cvt_pk_bf16_f32 v158, v136, v137
  v_mul_f32 v138, v143, v93
  v_mul_f32 v139, v143, v92
  v_fma_f32 v138, v142, v92, -v138
  v_fmac_f32 v139, v142, v93
  v_cvt_pk_bf16_f32 v162, v140, v141
  v_cvt_pk_bf16_f32 v166, v138, v139
  v_cvt_pk_bf16_f32 v155, v146, v147
  v_mul_f32 v144, v147, v103
  v_mul_f32 v145, v147, v102
  v_fma_f32 v144, v146, v102, -v144
  v_fmac_f32 v145, v146, v103
  v_mul_f32 v148, v151, v99
  v_mul_f32 v149, v151, v98
  v_fma_f32 v148, v150, v98, -v148
  v_fmac_f32 v149, v150, v99
  v_cvt_pk_bf16_f32 v159, v144, v145
  v_mul_f32 v146, v151, v101
  v_mul_f32 v147, v151, v100
  v_fma_f32 v146, v150, v100, -v146
  v_fmac_f32 v147, v150, v101
  v_cvt_pk_bf16_f32 v163, v148, v149
  v_cvt_pk_bf16_f32 v167, v146, v147
  ds_read_b128 v[72:75], v59 offset:512
  ds_read_b128 v[76:79], v59 offset:1536
  ds_read_b128 v[80:83], v59 offset:528
  ds_read_b128 v[84:87], v59 offset:1552
  ds_read_b128 v[88:91], v59 offset:544
  ds_read_b128 v[92:95], v59 offset:1568
  ds_read_b128 v[96:99], v59 offset:560
  ds_read_b128 v[100:103], v59 offset:1584
  s_waitcnt lgkmcnt(8)
  v_mul_f32 v136, v104, v50
  v_mul_f32 v137, v105, v50
  v_mul_f32 v140, v104, v51
  v_mul_f32 v141, v105, v51
  v_mul_f32 v144, v112, v50
  v_mul_f32 v145, v113, v50
  v_mul_f32 v148, v112, v51
  v_mul_f32 v149, v113, v51
  v_fract_f32 v137, v137
  v_exp_f32 v136, v136
  v_exp_f32 v140, v140
  v_fract_f32 v145, v145
  v_exp_f32 v144, v144
  v_exp_f32 v148, v148
  v_cos_f32 v138, v137
  v_sin_f32 v139, v137
  v_cos_f32 v142, v141
  v_sin_f32 v143, v141
  v_cos_f32 v146, v145
  v_sin_f32 v147, v145
  v_cos_f32 v150, v149
  v_sin_f32 v151, v149
  v_mul_f32 v138, v138, v136
  v_mul_f32_e64 v139, -v139, v136
  v_mul_f32 v142, v142, v140
  s_waitcnt vmcnt(0)
  s_barrier
  v_mul_f32 v143, v143, v140
  v_mul_f32 v146, v146, v144
  v_mul_f32_e64 v147, -v147, v144
  v_mul_f32 v150, v150, v148
  v_mul_f32 v151, v151, v148
  v_cvt_pk_bf16_f32 v168, v138, v139
  v_mul_f32 v136, v139, v111
  v_mul_f32 v137, v139, v110
  v_fma_f32 v136, v138, v110, -v136
  v_fmac_f32 v137, v138, v111
  v_mul_f32 v140, v143, v107
  v_mul_f32 v141, v143, v106
  v_fma_f32 v140, v142, v106, -v140
  v_fmac_f32 v141, v142, v107
  v_cvt_pk_bf16_f32 v172, v136, v137
  v_mul_f32 v138, v143, v109
  v_mul_f32 v139, v143, v108
  v_fma_f32 v138, v142, v108, -v138
  v_fmac_f32 v139, v142, v109
  v_cvt_pk_bf16_f32 v176, v140, v141
  v_cvt_pk_bf16_f32 v180, v138, v139
  v_cvt_pk_bf16_f32 v169, v146, v147
  v_mul_f32 v144, v147, v119
  v_mul_f32 v145, v147, v118
  v_fma_f32 v144, v146, v118, -v144
  v_fmac_f32 v145, v146, v119
  v_mul_f32 v148, v151, v115
  v_mul_f32 v149, v151, v114
  v_fma_f32 v148, v150, v114, -v148
  v_fmac_f32 v149, v150, v115
  v_cvt_pk_bf16_f32 v173, v144, v145
  v_mul_f32 v146, v151, v117
  v_mul_f32 v147, v151, v116
  v_fma_f32 v146, v150, v116, -v146
  v_fmac_f32 v147, v150, v117
  v_cvt_pk_bf16_f32 v177, v148, v149
  v_cvt_pk_bf16_f32 v181, v146, v147
  v_mfma_f32_16x16x32_bf16 v[200:203], v[152:155], v[160:163], 0
  v_mfma_f32_16x16x32_bf16 v[204:207], v[152:155], v[164:167], 0
  v_mfma_f32_16x16x32_bf16 v[208:211], v[156:159], v[160:163], 0
  v_mfma_f32_16x16x32_bf16 v[212:215], v[156:159], v[164:167], 0
  v_mul_f32 v136, v120, v50
  v_mul_f32 v137, v121, v50
  v_mul_f32 v140, v120, v51
  v_mul_f32 v141, v121, v51
  v_mul_f32 v144, v128, v50
  v_mul_f32 v145, v129, v50
  v_mul_f32 v148, v128, v51
  v_mul_f32 v149, v129, v51
  v_fract_f32 v137, v137
  v_exp_f32 v136, v136
  v_exp_f32 v140, v140
  v_fract_f32 v145, v145
  v_exp_f32 v144, v144
  v_exp_f32 v148, v148
  v_cos_f32 v138, v137
  v_sin_f32 v139, v137
  v_cos_f32 v142, v141
  v_sin_f32 v143, v141
  v_cos_f32 v146, v145
  v_sin_f32 v147, v145
  v_cos_f32 v150, v149
  v_sin_f32 v151, v149
  v_mul_f32 v138, v138, v136
  v_mul_f32_e64 v139, -v139, v136
  v_mul_f32 v142, v142, v140
  v_mul_f32 v143, v143, v140
  v_mul_f32 v146, v146, v144
  v_mul_f32_e64 v147, -v147, v144
  v_mul_f32 v150, v150, v148
  v_mul_f32 v151, v151, v148
  v_cvt_pk_bf16_f32 v170, v138, v139
  v_mul_f32 v136, v139, v127
  v_mul_f32 v137, v139, v126
  v_fma_f32 v136, v138, v126, -v136
  v_fmac_f32 v137, v138, v127
  v_mul_f32 v140, v143, v123
  v_mul_f32 v141, v143, v122
  v_fma_f32 v140, v142, v122, -v140
  v_fmac_f32 v141, v142, v123
  v_cvt_pk_bf16_f32 v174, v136, v137
  v_mul_f32 v138, v143, v125
  v_mul_f32 v139, v143, v124
  v_fma_f32 v138, v142, v124, -v138
  s_barrier
  v_fmac_f32 v139, v142, v125
  v_cvt_pk_bf16_f32 v178, v140, v141
  v_cvt_pk_bf16_f32 v182, v138, v139
  v_cvt_pk_bf16_f32 v171, v146, v147
  v_mul_f32 v144, v147, v135
  v_mul_f32 v145, v147, v134
  v_fma_f32 v144, v146, v134, -v144
  v_fmac_f32 v145, v146, v135
  v_mul_f32 v148, v151, v131
  v_mul_f32 v149, v151, v130
  v_fma_f32 v148, v150, v130, -v148
  v_fmac_f32 v149, v150, v131
  v_cvt_pk_bf16_f32 v175, v144, v145
  v_mul_f32 v146, v151, v133
  v_mul_f32 v147, v151, v132
  v_fma_f32 v146, v150, v132, -v146
  v_fmac_f32 v147, v150, v133
  v_cvt_pk_bf16_f32 v179, v148, v149
  v_cvt_pk_bf16_f32 v183, v146, v147
  ds_read_b128 v[104:107], v59 offset:768
  ds_read_b128 v[108:111], v59 offset:1792
  ds_read_b128 v[112:115], v59 offset:784
  ds_read_b128 v[116:119], v59 offset:1808
  ds_read_b128 v[120:123], v59 offset:800
  ds_read_b128 v[124:127], v59 offset:1824
  ds_read_b128 v[128:131], v59 offset:816
  ds_read_b128 v[132:135], v59 offset:1840
  s_waitcnt lgkmcnt(8)
  v_mul_f32 v136, v72, v50
  v_mul_f32 v137, v73, v50
  v_mul_f32 v140, v72, v51
  v_mul_f32 v141, v73, v51
  v_mul_f32 v144, v80, v50
  v_mul_f32 v145, v81, v50
  v_mul_f32 v148, v80, v51
  v_mul_f32 v149, v81, v51
  v_fract_f32 v137, v137
  v_exp_f32 v136, v136
  v_exp_f32 v140, v140
  v_fract_f32 v145, v145
  v_exp_f32 v144, v144
  v_exp_f32 v148, v148
  v_cos_f32 v138, v137
  v_sin_f32 v139, v137
  v_cos_f32 v142, v141
  v_sin_f32 v143, v141
  v_cos_f32 v146, v145
  v_sin_f32 v147, v145
  v_cos_f32 v150, v149
  v_sin_f32 v151, v149
  v_mul_f32 v138, v138, v136
  v_mul_f32_e64 v139, -v139, v136
  v_mul_f32 v142, v142, v140
  v_mul_f32 v143, v143, v140
  v_mul_f32 v146, v146, v144
  v_mul_f32_e64 v147, -v147, v144
  v_mul_f32 v150, v150, v148
  v_mul_f32 v151, v151, v148
  v_cvt_pk_bf16_f32 v152, v138, v139
  v_mul_f32 v136, v139, v79
  v_mul_f32 v137, v139, v78
  v_fma_f32 v136, v138, v78, -v136
  v_fmac_f32 v137, v138, v79
  v_mul_f32 v140, v143, v75
  v_mul_f32 v141, v143, v74
  v_fma_f32 v140, v142, v74, -v140
  v_fmac_f32 v141, v142, v75
  v_cvt_pk_bf16_f32 v156, v136, v137
  v_mul_f32 v138, v143, v77
  v_mul_f32 v139, v143, v76
  v_fma_f32 v138, v142, v76, -v138
  v_fmac_f32 v139, v142, v77
  v_cvt_pk_bf16_f32 v160, v140, v141
  v_cvt_pk_bf16_f32 v164, v138, v139
  v_cvt_pk_bf16_f32 v153, v146, v147
  v_mul_f32 v144, v147, v87
  v_mul_f32 v145, v147, v86
  v_fma_f32 v144, v146, v86, -v144
  v_fmac_f32 v145, v146, v87
  v_mul_f32 v148, v151, v83
  v_mul_f32 v149, v151, v82
  v_fma_f32 v148, v150, v82, -v148
  v_fmac_f32 v149, v150, v83
  v_cvt_pk_bf16_f32 v157, v144, v145
  v_mul_f32 v146, v151, v85
  s_barrier
  buffer_load_dword v29, v63, s[92:95], s29 offen
  v_mul_f32 v147, v151, v84
  v_fma_f32 v146, v150, v84, -v146
  v_fmac_f32 v147, v150, v85
  v_cvt_pk_bf16_f32 v161, v148, v149
  v_cvt_pk_bf16_f32 v165, v146, v147
  v_mfma_f32_16x16x32_bf16 v[200:203], v[168:171], v[176:179], v[200:203]
  v_mfma_f32_16x16x32_bf16 v[204:207], v[168:171], v[180:183], v[204:207]
  v_mfma_f32_16x16x32_bf16 v[208:211], v[172:175], v[176:179], v[208:211]
  v_mfma_f32_16x16x32_bf16 v[212:215], v[172:175], v[180:183], v[212:215]
  v_mul_f32 v136, v88, v50
  v_mul_f32 v137, v89, v50
  v_mul_f32 v140, v88, v51
  v_mul_f32 v141, v89, v51
  v_mul_f32 v144, v96, v50
  v_mul_f32 v145, v97, v50
  v_mul_f32 v148, v96, v51
  v_mul_f32 v149, v97, v51
  v_fract_f32 v137, v137
  v_exp_f32 v136, v136
  v_exp_f32 v140, v140
  v_fract_f32 v145, v145
  v_exp_f32 v144, v144
  v_exp_f32 v148, v148
  v_cos_f32 v138, v137
  v_sin_f32 v139, v137
  v_cos_f32 v142, v141
  v_sin_f32 v143, v141
  v_cos_f32 v146, v145
  v_sin_f32 v147, v145
  v_cos_f32 v150, v149
  v_sin_f32 v151, v149
  v_mul_f32 v138, v138, v136
  v_mul_f32_e64 v139, -v139, v136
  v_mul_f32 v142, v142, v140
  v_mul_f32 v143, v143, v140
  v_mul_f32 v146, v146, v144
  v_mul_f32_e64 v147, -v147, v144
  v_mul_f32 v150, v150, v148
  v_mul_f32 v151, v151, v148
  v_cvt_pk_bf16_f32 v154, v138, v139
  v_mul_f32 v136, v139, v95
  v_mul_f32 v137, v139, v94
  v_fma_f32 v136, v138, v94, -v136
  v_fmac_f32 v137, v138, v95
  v_mul_f32 v140, v143, v91
  v_mul_f32 v141, v143, v90
  v_fma_f32 v140, v142, v90, -v140
  v_fmac_f32 v141, v142, v91
  v_cvt_pk_bf16_f32 v158, v136, v137
  v_mul_f32 v138, v143, v93
  v_mul_f32 v139, v143, v92
  v_fma_f32 v138, v142, v92, -v138
  v_fmac_f32 v139, v142, v93
  v_cvt_pk_bf16_f32 v162, v140, v141
  v_cvt_pk_bf16_f32 v166, v138, v139
  v_cvt_pk_bf16_f32 v155, v146, v147
  v_mul_f32 v144, v147, v103
  v_mul_f32 v145, v147, v102
  v_fma_f32 v144, v146, v102, -v144
  v_fmac_f32 v145, v146, v103
  v_mul_f32 v148, v151, v99
  v_mul_f32 v149, v151, v98
  v_fma_f32 v148, v150, v98, -v148
  v_fmac_f32 v149, v150, v99
  v_cvt_pk_bf16_f32 v159, v144, v145
  v_mul_f32 v146, v151, v101
  v_mul_f32 v147, v151, v100
  v_fma_f32 v146, v150, v100, -v146
  v_fmac_f32 v147, v150, v101
  v_cvt_pk_bf16_f32 v163, v148, v149
  v_cvt_pk_bf16_f32 v167, v146, v147
  s_waitcnt lgkmcnt(0)
  s_load_dwordx2 s[36:37], s[8:9], 128
  v_mul_f32 v136, v104, v50
  v_mul_f32 v137, v105, v50
  v_mul_f32 v140, v104, v51
  v_mul_f32 v141, v105, v51
  v_mul_f32 v144, v112, v50
  v_mul_f32 v145, v113, v50
  v_mul_f32 v148, v112, v51
  v_mul_f32 v149, v113, v51
  v_fract_f32 v137, v137
  v_exp_f32 v136, v136
  v_exp_f32 v140, v140
  s_barrier
  s_add_u32 m0, s20, 32768
  s_add_u32 s44, s28, 0
  buffer_load_dwordx4 v62, s[92:95], s44 offen lds
  s_add_u32 m0, s20, 33792
  s_add_u32 s44, s28, 8192
  buffer_load_dwordx4 v62, s[92:95], s44 offen lds
  s_add_u32 m0, s20, 34816
  s_add_u32 s44, s28, 16384
  buffer_load_dwordx4 v62, s[92:95], s44 offen lds
  s_add_u32 m0, s20, 35840
  s_add_u32 s44, s28, 24576
  buffer_load_dwordx4 v62, s[92:95], s44 offen lds
  v_fract_f32 v145, v145
  v_exp_f32 v144, v144
  v_exp_f32 v148, v148
  v_cos_f32 v138, v137
  v_sin_f32 v139, v137
  v_cos_f32 v142, v141
  v_sin_f32 v143, v141
  v_cos_f32 v146, v145
  v_sin_f32 v147, v145
  v_cos_f32 v150, v149
  v_sin_f32 v151, v149
  v_mul_f32 v138, v138, v136
  v_mul_f32_e64 v139, -v139, v136
  v_mul_f32 v142, v142, v140
  v_mul_f32 v143, v143, v140
  v_mul_f32 v146, v146, v144
  v_mul_f32_e64 v147, -v147, v144
  v_mul_f32 v150, v150, v148
  v_mul_f32 v151, v151, v148
  v_cvt_pk_bf16_f32 v168, v138, v139
  v_mul_f32 v136, v139, v111
  v_mul_f32 v137, v139, v110
  v_fma_f32 v136, v138, v110, -v136
  v_fmac_f32 v137, v138, v111
  v_mul_f32 v140, v143, v107
  v_mul_f32 v141, v143, v106
  v_fma_f32 v140, v142, v106, -v140
  v_fmac_f32 v141, v142, v107
  v_cvt_pk_bf16_f32 v172, v136, v137
  v_mul_f32 v138, v143, v109
  v_mul_f32 v139, v143, v108
  v_fma_f32 v138, v142, v108, -v138
  v_fmac_f32 v139, v142, v109
  v_cvt_pk_bf16_f32 v176, v140, v141
  v_cvt_pk_bf16_f32 v180, v138, v139
  v_cvt_pk_bf16_f32 v169, v146, v147
  v_mul_f32 v144, v147, v119
  v_mul_f32 v145, v147, v118
  v_fma_f32 v144, v146, v118, -v144
  v_fmac_f32 v145, v146, v119
  v_mul_f32 v148, v151, v115
  v_mul_f32 v149, v151, v114
  v_fma_f32 v148, v150, v114, -v148
  v_fmac_f32 v149, v150, v115
  v_cvt_pk_bf16_f32 v173, v144, v145
  v_mul_f32 v146, v151, v117
  v_mul_f32 v147, v151, v116
  v_fma_f32 v146, v150, v116, -v146
  v_fmac_f32 v147, v150, v117
  v_cvt_pk_bf16_f32 v177, v148, v149
  v_cvt_pk_bf16_f32 v181, v146, v147
  v_mfma_f32_16x16x32_bf16 v[200:203], v[152:155], v[160:163], v[200:203]
  v_mfma_f32_16x16x32_bf16 v[204:207], v[152:155], v[164:167], v[204:207]
  v_mfma_f32_16x16x32_bf16 v[208:211], v[156:159], v[160:163], v[208:211]
  v_mfma_f32_16x16x32_bf16 v[212:215], v[156:159], v[164:167], v[212:215]
  v_mul_f32 v136, v120, v50
  v_mul_f32 v137, v121, v50
  v_mul_f32 v140, v120, v51
  v_mul_f32 v141, v121, v51
  v_mul_f32 v144, v128, v50
  v_mul_f32 v145, v129, v50
  v_mul_f32 v148, v128, v51
  v_mul_f32 v149, v129, v51
  v_fract_f32 v137, v137
  v_exp_f32 v136, v136
  v_exp_f32 v140, v140
  s_barrier
  s_add_u32 m0, s20, 0
  s_add_u32 s44, s28, 32768
  buffer_load_dwordx4 v62, s[92:95], s44 offen lds
  s_add_u32 m0, s20, 1024
  s_add_u32 s44, s28, 40960
  buffer_load_dwordx4 v62, s[92:95], s44 offen lds
  s_add_u32 m0, s20, 2048
  s_add_u32 s44, s28, 49152
  buffer_load_dwordx4 v62, s[92:95], s44 offen lds
  s_add_u32 m0, s20, 3072
  s_add_u32 s44, s28, 57344
  buffer_load_dwordx4 v62, s[92:95], s44 offen lds
  s_add_u32 m0, s21, 12288
  s_add_u32 s44, s28, 65536
  buffer_load_dwordx4 v62, s[92:95], s44 offen lds
  s_add_u32 m0, s21, 13312
  s_add_u32 s44, s28, 73728
  buffer_load_dwordx4 v62, s[92:95], s44 offen lds
  s_add_u32 m0, s21, 14336
  s_add_u32 s44, s28, 81920
  buffer_load_dwordx4 v62, s[92:95], s44 offen lds
  v_fract_f32 v145, v145
  s_barrier
  v_min_u32 v63, 4480, v63
  buffer_load_dword v29, v63, s[92:95], s30 offen
  s_add_u32 m0, s20, 16384
  s_add_u32 s44, s28, 90112
  buffer_load_dwordx4 v62, s[92:95], s44 offen lds
  s_add_u32 m0, s20, 17408
  s_add_u32 s44, s28, 98304
  buffer_load_dwordx4 v62, s[92:95], s44 offen lds
  s_add_u32 m0, s20, 18432
  s_add_u32 s44, s28, 106496
  buffer_load_dwordx4 v62, s[92:95], s44 offen lds
  s_add_u32 m0, s20, 19456
  s_add_u32 s44, s28, 114688
  buffer_load_dwordx4 v62, s[92:95], s44 offen lds
  s_setprio 3
  s_add_u32 s55, s54, 0
  buffer_load_dwordx4 v[232:235], v30, s[12:15], s55 offen sc1
  s_setprio 0
  s_setprio 3
  s_add_u32 s55, s54, 294912
  buffer_load_dwordx4 v[236:239], v30, s[12:15], s55 offen sc1
  s_setprio 0
  s_setprio 3
  s_add_u32 s55, s54, 589824
  buffer_load_dwordx4 v[240:243], v30, s[12:15], s55 offen sc1
  s_setprio 0
  s_setprio 3
  s_add_u32 s55, s54, 884736
  buffer_load_dwordx4 v[244:247], v30, s[12:15], s55 offen sc1
  s_setprio 0
  v_exp_f32 v144, v144
  v_exp_f32 v148, v148
  v_cos_f32 v138, v137
  s_barrier
  v_sin_f32 v139, v137
  v_cos_f32 v142, v141
  v_sin_f32 v143, v141
  v_cos_f32 v146, v145
  v_sin_f32 v147, v145
  v_cos_f32 v150, v149
  v_sin_f32 v151, v149
  v_mul_f32 v138, v138, v136
  v_mul_f32_e64 v139, -v139, v136
  v_mul_f32 v142, v142, v140
  v_mul_f32 v143, v143, v140
  v_mul_f32 v146, v146, v144
  v_mul_f32_e64 v147, -v147, v144
  v_mul_f32 v150, v150, v148
  v_mul_f32 v151, v151, v148
  v_cvt_pk_bf16_f32 v170, v138, v139
  v_mul_f32 v136, v139, v127
  v_mul_f32 v137, v139, v126
  v_fma_f32 v136, v138, v126, -v136
  v_fmac_f32 v137, v138, v127
  v_mul_f32 v140, v143, v123
  v_mul_f32 v141, v143, v122
  v_fma_f32 v140, v142, v122, -v140
  v_fmac_f32 v141, v142, v123
  v_cvt_pk_bf16_f32 v174, v136, v137
  v_mul_f32 v138, v143, v125
  v_mul_f32 v139, v143, v124
  v_fma_f32 v138, v142, v124, -v138
  v_fmac_f32 v139, v142, v125
  v_cvt_pk_bf16_f32 v178, v140, v141
  v_cvt_pk_bf16_f32 v182, v138, v139
  v_cvt_pk_bf16_f32 v171, v146, v147
  v_mul_f32 v144, v147, v135
  v_mul_f32 v145, v147, v134
  v_fma_f32 v144, v146, v134, -v144
  v_fmac_f32 v145, v146, v135
  v_mul_f32 v148, v151, v131
  v_mul_f32 v149, v151, v130
  v_fma_f32 v148, v150, v130, -v148
  v_fmac_f32 v149, v150, v131
  v_cvt_pk_bf16_f32 v175, v144, v145
  v_mul_f32 v146, v151, v133
  v_mul_f32 v147, v151, v132
  v_fma_f32 v146, v150, v132, -v146
  v_fmac_f32 v147, v150, v133
  v_cvt_pk_bf16_f32 v179, v148, v149
  v_cvt_pk_bf16_f32 v183, v146, v147
  s_nop 0
  v_mfma_f32_16x16x32_bf16 v[200:203], v[168:171], v[176:179], v[200:203]
  v_mfma_f32_16x16x32_bf16 v[204:207], v[168:171], v[180:183], v[204:207]
  v_mfma_f32_16x16x32_bf16 v[208:211], v[172:175], v[176:179], v[208:211]
  v_mfma_f32_16x16x32_bf16 v[212:215], v[172:175], v[180:183], v[212:215]
  s_nop 4
  ds_write_b128 v32, v[200:203] offset:0
  ds_write_b128 v32, v[204:207] offset:256
  ds_write_b128 v32, v[208:211] offset:512
  ds_write_b128 v32, v[212:215] offset:768
  s_setprio 1
  s_add_u32 m0, s21, 0
  s_add_u32 s44, s28, 122880
  buffer_load_dwordx4 v62, s[92:95], s44 offen lds
  s_add_u32 m0, s21, 1024
  s_add_u32 s44, s28, 131072
  buffer_load_dwordx4 v62, s[92:95], s44 offen lds
  s_add_u32 m0, s21, 2048
  s_add_u32 s44, s28, 139264
  buffer_load_dwordx4 v62, s[92:95], s44 offen lds
  s_add_u32 m0, s21, 24576
  s_add_u32 s44, s28, 147456
  buffer_load_dwordx4 v62, s[92:95], s44 offen lds
  ds_write_b32 v58, v58 offset:16
  s_waitcnt lgkmcnt(0)
  s_cmp_eq_u32 s36, 0
  s_cbranch_scc1 S_tagslow
S_tagok:
S_xw:
  ds_read_b32 v28, v27 offset:16
  s_waitcnt lgkmcnt(0)
  v_readfirstlane_b32 s44, v28
  s_nop 0
  s_cmp_eq_u32 s44, 0
  s_cbranch_scc1 S_xw
  s_cmp_lg_u32 s6, 0
  s_cbranch_scc1 S_par1
  ds_read_b128 v[216:219], v33 offset:0
  ds_read_b128 v[64:67], v33 offset:4096
  ds_read_b128 v[220:223], v33 offset:1024
  ds_read_b128 v[68:71], v33 offset:5120
  ds_read_b128 v[224:227], v33 offset:2048
  ds_read_b128 v[72:75], v33 offset:6144
  v_mov_b32 v57, 0
  ds_write_b32 v35, v57
  s_waitcnt lgkmcnt(1)
  v_add_f32 v216, v216, v64
  v_add_f32 v217, v217, v65
  v_add_f32 v218, v218, v66
  v_add_f32 v219, v219, v67
  v_add_f32 v220, v220, v68
  v_add_f32 v221, v221, v69
  v_add_f32 v222, v222, v70
  v_add_f32 v223, v223, v71
  v_add_f32 v224, v224, v72
  v_add_f32 v225, v225, v73
  v_add_f32 v226, v226, v74
  v_add_f32 v227, v227, v75
  v_cndmask_b32 v217, v217, v216, s[56:57]
  v_cndmask_b32 v219, v219, v220, s[56:57]
  v_cndmask_b32 v221, v221, v220, s[56:57]
  v_cndmask_b32 v223, v223, v224, s[56:57]
  v_mov_b32 v228, v224
  v_mov_b32 v229, v224
  s_mov_b64 exec, 1
  ds_write_b32 v41, v216
  v_mov_b32 v216, 0
  s_mov_b64 exec, -1
  v_mov_b32_dpp v228, v217 wave_shl:1 row_mask:0xf bank_mask:0xf
  v_mov_b32_dpp v229, v218 wave_shl:1 row_mask:0xf bank_mask:0xf
  v_cvt_pk_bf16_f32 v104, v225, v225
  v_cvt_pk_bf16_f32 v105, v225, v226
  v_cvt_pk_bf16_f32 v106, v226, v226
  v_cvt_pk_bf16_f32 v107, v227, v227
  ds_write_b128 v34, v[104:107] offset:1024
  s_add_u32 m0, s21, 25600
  s_add_u32 s44, s28, 155648
  buffer_load_dwordx4 v62, s[92:95], s44 offen lds
  s_add_u32 m0, s21, 26624
  s_add_u32 s44, s28, 163840
  buffer_load_dwordx4 v62, s[92:95], s44 offen lds
  v_cvt_pk_bf16_f32 v108, v225, v225
  v_cvt_pk_bf16_f32 v109, v226, v226
  v_cvt_pk_bf16_f32 v110, v226, v227
  v_cvt_pk_bf16_f32 v111, v227, v227
  ds_write_b128 v34, v[108:111] offset:5184
  s_add_u32 m0, s21, 36864
  s_add_u32 s44, s28, 172032
  buffer_load_dwordx4 v62, s[92:95], s44 offen lds
  s_add_u32 m0, s21, 37888
  s_add_u32 s44, s28, 180224
  buffer_load_dwordx4 v62, s[92:95], s44 offen lds
  v_cvt_pk_bf16_f32 v112, v225, v226
  v_cvt_pk_bf16_f32 v113, v226, v226
  v_cvt_pk_bf16_f32 v114, v227, v227
  v_cvt_pk_bf16_f32 v115, v227, v227
  ds_write_b128 v34, v[112:115] offset:9344
  s_add_u32 m0, s21, 38912
  s_add_u32 s44, s28, 188416
  buffer_load_dwordx4 v62, s[92:95], s44 offen lds
  v_cvt_pk_bf16_f32 v116, v226, v226
  v_cvt_pk_bf16_f32 v117, v226, v227
  v_cvt_pk_bf16_f32 v118, v227, v227
  v_cvt_pk_bf16_f32 v119, v227, v227
  ds_write_b128 v34, v[116:119] offset:13504
  v_cvt_pk_bf16_f32 v88, v216, v217
  v_cvt_pk_bf16_f32 v89, v218, v219
  v_cvt_pk_bf16_f32 v90, v220, v221
  v_cvt_pk_bf16_f32 v91, v222, v223
  ds_write_b128 v34, v[88:91] offset:0
  v_cvt_pk_bf16_f32 v92, v217, v218
  v_cvt_pk_bf16_f32 v93, v219, v220
  v_cvt_pk_bf16_f32 v94, v221, v222
  v_cvt_pk_bf16_f32 v95, v223, v224
  ds_write_b128 v34, v[92:95] offset:4160
  v_cvt_pk_bf16_f32 v96, v218, v219
  v_cvt_pk_bf16_f32 v97, v220, v221
  v_cvt_pk_bf16_f32 v98, v222, v223
  v_cvt_pk_bf16_f32 v99, v224, v228
  ds_write_b128 v34, v[96:99] offset:8320
  v_cvt_pk_bf16_f32 v100, v219, v220
  v_cvt_pk_bf16_f32 v101, v221, v222
  v_cvt_pk_bf16_f32 v102, v223, v224
  v_cvt_pk_bf16_f32 v103, v228, v229
  ds_write_b128 v34, v[100:103] offset:12480
  s_mov_b64 exec, 1
  ds_write_b32 v42, v88 offset:8348
  ds_write_b32 v42, v92 offset:12508
  s_mov_b64 exec, -1
  s_branch S_parj
S_par1:
  ds_read_b128 v[228:231], v33 offset:3072
  ds_read_b128 v[64:67], v33 offset:7168
  s_waitcnt lgkmcnt(0)
  v_add_f32 v228, v228, v64
  v_add_f32 v229, v229, v65
  v_add_f32 v230, v230, v66
  v_add_f32 v231, v231, v67
  v_cndmask_b32 v216, v228, v229, s[58:59]
  v_cndmask_b32 v217, v230, v231, s[58:59]
  v_cvt_pk_bf16_f32 v88, v228, v228
  v_cvt_pk_bf16_f32 v89, v228, v228
  v_cvt_pk_bf16_f32 v90, v216, v229
  v_cvt_pk_bf16_f32 v91, v229, v229
  ds_write_b128 v34, v[88:91] offset:0
  s_add_u32 m0, s21, 25600
  s_add_u32 s44, s28, 155648
  buffer_load_dwordx4 v62, s[92:95], s44 offen lds
  s_add_u32 m0, s21, 26624
  s_add_u32 s44, s28, 163840
  buffer_load_dwordx4 v62, s[92:95], s44 offen lds
  v_cvt_pk_bf16_f32 v92, v228, v228
  v_cvt_pk_bf16_f32 v93, v228, v216
  v_cvt_pk_bf16_f32 v94, v229, v229
  v_cvt_pk_bf16_f32 v95, v229, v229
  ds_write_b128 v34, v[92:95] offset:4160
  s_add_u32 m0, s21, 36864
  s_add_u32 s44, s28, 172032
  buffer_load_dwordx4 v62, s[92:95], s44 offen lds
  s_add_u32 m0, s21, 37888
  s_add_u32 s44, s28, 180224
  buffer_load_dwordx4 v62, s[92:95], s44 offen lds
  v_cvt_pk_bf16_f32 v96, v228, v228
  v_cvt_pk_bf16_f32 v97, v216, v229
  v_cvt_pk_bf16_f32 v98, v229, v229
  v_cvt_pk_bf16_f32 v99, v229, v229
  ds_write_b128 v34, v[96:99] offset:8320
  s_add_u32 m0, s21, 38912
  s_add_u32 s44, s28, 188416
  buffer_load_dwordx4 v62, s[92:95], s44 offen lds
  v_cvt_pk_bf16_f32 v100, v228, v216
  v_cvt_pk_bf16_f32 v101, v229, v229
  v_cvt_pk_bf16_f32 v102, v229, v229
  v_cvt_pk_bf16_f32 v103, v229, v229
  ds_write_b128 v34, v[100:103] offset:12480
  v_cvt_pk_bf16_f32 v104, v230, v230
  v_cvt_pk_bf16_f32 v105, v230, v230
  v_cvt_pk_bf16_f32 v106, v217, v231
  v_cvt_pk_bf16_f32 v107, v231, v231
  ds_write_b128 v34, v[104:107] offset:1024
  v_cvt_pk_bf16_f32 v108, v230, v230
  v_cvt_pk_bf16_f32 v109, v230, v217
  v_cvt_pk_bf16_f32 v110, v231, v231
  v_cvt_pk_bf16_f32 v111, v231, v231
  ds_write_b128 v34, v[108:111] offset:5184
  v_cvt_pk_bf16_f32 v112, v230, v230
  v_cvt_pk_bf16_f32 v113, v217, v231
  v_cvt_pk_bf16_f32 v114, v231, v231
  v_cvt_pk_bf16_f32 v115, v231, v231
  ds_write_b128 v34, v[112:115] offset:9344
  v_cvt_pk_bf16_f32 v116, v230, v217
  v_cvt_pk_bf16_f32 v117, v231, v231
  v_cvt_pk_bf16_f32 v118, v231, v231
  v_cvt_pk_bf16_f32 v119, v231, v231
  ds_write_b128 v34, v[116:119] offset:13504
S_parj:
  s_lshl_b32 s7, s43, 16
  s_and_b32 s34, s43, s41
  s_cmp_eq_u32 s5, 0
  s_cselect_b32 s43, s7, s34
  s_lshl1_add_u32 s7, s3, s5
  s_mul_i32 s7, s7, 4608
  s_add_u32 s7, s7, 11010048
  s_lshl_b32 s34, s6, 9
  s_add_u32 s7, s7, s34
  s_lshl_b32 s34, s6, 10
  s_sub_u32 s34, 1024, s34
  v_lshrrev_b32 v54, 5, v1
  v_mad_u32_u24 v54, v54, s34, v60
  s_lshl2_add_u32 s34, s3, s32
  s_lshl_b32 s34, s34, 7
  s_add_u32 s34, s34, 6029312
  v_mov_b32 v56, s36
  v_mov_b32 v57, s37
  s_mov_b32 s35, 0
  s_waitcnt vmcnt(9)
S_uchk:
  v_cmp_ne_u64 vcc, s[36:37], v[234:235]
  v_cmp_ne_u64 s[44:45], s[36:37], v[238:239]
  v_cmp_ne_u64 s[46:47], s[36:37], v[242:243]
  v_cmp_ne_u64 s[48:49], s[36:37], v[246:247]
  s_or_b64 vcc, vcc, s[44:45]
  s_or_b64 vcc, vcc, s[46:47]
  s_or_b64 vcc, vcc, s[48:49]
  s_cbranch_vccnz S_uslow
S_uok:
  s_mov_b32 s35, 0
  ds_write_b64 v31, v[232:233] offset:0
  ds_write_b64 v31, v[236:237] offset:256
  ds_write_b64 v31, v[240:241] offset:512
  ds_write_b64 v31, v[244:245] offset:768
  s_waitcnt vmcnt(0) lgkmcnt(0)
  s_setprio 1
  s_barrier
  ds_read_b128 v[96:99], v37 offset:192
  ds_read_b64_tr_b16 v[64:65], v36 offset:8
  ds_read_b64_tr_b16 v[66:67], v36 offset:0
  ds_read_b128 v[100:103], v37 offset:704
  ds_read_b64_tr_b16 v[68:69], v36 offset:520
  ds_read_b64_tr_b16 v[70:71], v36 offset:512
  ds_read_b128 v[104:107], v37 offset:1216
  ds_read_b64_tr_b16 v[72:73], v36 offset:1032
  ds_read_b64_tr_b16 v[74:75], v36 offset:1024
  ds_read_b128 v[108:111], v37 offset:1728
  ds_read_b64_tr_b16 v[76:77], v36 offset:1544
  ds_read_b64_tr_b16 v[78:79], v36 offset:1536
  ds_read_b128 v[112:115], v37 offset:2240
  ds_read_b64_tr_b16 v[80:81], v36 offset:2056
  ds_read_b64_tr_b16 v[82:83], v36 offset:2048
  ds_read_b128 v[116:119], v37 offset:2752
  ds_read_b64_tr_b16 v[84:85], v36 offset:2568
  ds_read_b64_tr_b16 v[86:87], v36 offset:2560
  ds_read_b128 v[120:123], v37 offset:3264
  ds_read_b64_tr_b16 v[88:89], v36 offset:3080
  ds_read_b64_tr_b16 v[90:91], v36 offset:3072
  ds_read_b128 v[124:127], v37 offset:3776
  ds_read_b64_tr_b16 v[92:93], v36 offset:3592
  ds_read_b64_tr_b16 v[94:95], v36 offset:3584
  s_setprio 3
  s_waitcnt lgkmcnt(15)
  v_mfma_f32_16x16x32_bf16 v[192:195], v[64:67], v[96:99], 0
  v_mfma_f32_16x16x32_bf16 v[196:199], v[64:67], v[100:103], 0
  v_mfma_f32_16x16x32_bf16 v[196:199], v[68:71], v[96:99], v[196:199]
  v_mfma_f32_16x16x32_bf16 v[200:203], v[68:71], v[100:103], 0
  v_mfma_f32_16x16x32_bf16 v[200:203], v[64:67], v[104:107], v[200:203]
  v_mfma_f32_16x16x32_bf16 v[204:207], v[68:71], v[104:107], 0
  v_mfma_f32_16x16x32_bf16 v[200:203], v[72:75], v[96:99], v[200:203]
  v_mfma_f32_16x16x32_bf16 v[204:207], v[72:75], v[100:103], v[204:207]
  v_mfma_f32_16x16x32_bf16 v[208:211], v[72:75], v[104:107], 0
  ds_read_b128 v[160:163], v37 offset:128
  s_waitcnt lgkmcnt(13)
  v_mfma_f32_16x16x32_bf16 v[204:207], v[64:67], v[108:111], v[204:207]
  ds_read_b64_tr_b16 v[128:129], v36 offset:72
  v_mfma_f32_16x16x32_bf16 v[208:211], v[68:71], v[108:111], v[208:211]
  ds_read_b64_tr_b16 v[130:131], v36 offset:64
  v_mfma_f32_16x16x32_bf16 v[212:215], v[72:75], v[108:111], 0
  ds_read_b128 v[164:167], v37 offset:640
  v_mfma_f32_16x16x32_bf16 v[204:207], v[76:79], v[96:99], v[204:207]
  ds_read_b64_tr_b16 v[132:133], v36 offset:584
  v_mfma_f32_16x16x32_bf16 v[208:211], v[76:79], v[100:103], v[208:211]
  ds_read_b64_tr_b16 v[134:135], v36 offset:576
  v_mfma_f32_16x16x32_bf16 v[212:215], v[76:79], v[104:107], v[212:215]
  ds_read_b128 v[168:171], v37 offset:1152
  v_mfma_f32_16x16x32_bf16 v[216:219], v[76:79], v[108:111], 0
  ds_read_b64_tr_b16 v[136:137], v36 offset:1096
  s_waitcnt lgkmcnt(15)
  v_mfma_f32_16x16x32_bf16 v[208:211], v[64:67], v[112:115], v[208:211]
  ds_read_b64_tr_b16 v[138:139], v36 offset:1088
  v_mfma_f32_16x16x32_bf16 v[212:215], v[68:71], v[112:115], v[212:215]
  ds_read_b128 v[172:175], v37 offset:1664
  v_mfma_f32_16x16x32_bf16 v[216:219], v[72:75], v[112:115], v[216:219]
  ds_read_b64_tr_b16 v[140:141], v36 offset:1608
  v_mfma_f32_16x16x32_bf16 v[220:223], v[76:79], v[112:115], 0
  ds_read_b64_tr_b16 v[142:143], v36 offset:1600
  v_mfma_f32_16x16x32_bf16 v[208:211], v[80:83], v[96:99], v[208:211]
  ds_read_b128 v[176:179], v37 offset:2176
  v_mfma_f32_16x16x32_bf16 v[212:215], v[80:83], v[100:103], v[212:215]
  ds_read_b64_tr_b16 v[144:145], v36 offset:2120
  v_mfma_f32_16x16x32_bf16 v[216:219], v[80:83], v[104:107], v[216:219]
  ds_read_b64_tr_b16 v[146:147], v36 offset:2112
  v_mfma_f32_16x16x32_bf16 v[220:223], v[80:83], v[108:111], v[220:223]
  ds_read_b128 v[180:183], v37 offset:2688
  s_waitcnt lgkmcnt(15)
  v_mfma_f32_16x16x32_bf16 v[212:215], v[64:67], v[116:119], v[212:215]
  ds_read_b64_tr_b16 v[148:149], v36 offset:2632
  v_mfma_f32_16x16x32_bf16 v[216:219], v[68:71], v[116:119], v[216:219]
  ds_read_b64_tr_b16 v[150:151], v36 offset:2624
  v_mfma_f32_16x16x32_bf16 v[220:223], v[72:75], v[116:119], v[220:223]
  ds_read_b128 v[184:187], v37 offset:3200
  v_mfma_f32_16x16x32_bf16 v[212:215], v[84:87], v[96:99], v[212:215]
  ds_read_b64_tr_b16 v[152:153], v36 offset:3144
  v_mfma_f32_16x16x32_bf16 v[216:219], v[84:87], v[100:103], v[216:219]
  ds_read_b64_tr_b16 v[154:155], v36 offset:3136
  v_mfma_f32_16x16x32_bf16 v[220:223], v[84:87], v[104:107], v[220:223]
  ds_read_b128 v[188:191], v37 offset:3712
  v_mfma_f32_16x16x32_bf16 v[216:219], v[64:67], v[120:123], v[216:219]
  ds_read_b64_tr_b16 v[156:157], v36 offset:3656
  v_mfma_f32_16x16x32_bf16 v[220:223], v[68:71], v[120:123], v[220:223]
  ds_read_b64_tr_b16 v[158:159], v36 offset:3648
  v_mfma_f32_16x16x32_bf16 v[216:219], v[88:91], v[96:99], v[216:219]
  v_mfma_f32_16x16x32_bf16 v[220:223], v[88:91], v[100:103], v[220:223]
  v_mfma_f32_16x16x32_bf16 v[220:223], v[64:67], v[124:127], v[220:223]
  v_mfma_f32_16x16x32_bf16 v[220:223], v[92:95], v[96:99], v[220:223]
  s_waitcnt lgkmcnt(15)
  v_mfma_f32_16x16x32_bf16 v[192:195], v[128:131], v[160:163], v[192:195]
  v_mfma_f32_16x16x32_bf16 v[196:199], v[128:131], v[164:167], v[196:199]
  v_mfma_f32_16x16x32_bf16 v[196:199], v[132:135], v[160:163], v[196:199]
  v_mfma_f32_16x16x32_bf16 v[200:203], v[132:135], v[164:167], v[200:203]
  v_mfma_f32_16x16x32_bf16 v[200:203], v[128:131], v[168:171], v[200:203]
  v_mfma_f32_16x16x32_bf16 v[204:207], v[132:135], v[168:171], v[204:207]
  v_mfma_f32_16x16x32_bf16 v[200:203], v[136:139], v[160:163], v[200:203]
  v_mfma_f32_16x16x32_bf16 v[204:207], v[136:139], v[164:167], v[204:207]
  v_mfma_f32_16x16x32_bf16 v[208:211], v[136:139], v[168:171], v[208:211]
  ds_read_b128 v[96:99], v37 offset:64
  s_waitcnt lgkmcnt(13)
  v_mfma_f32_16x16x32_bf16 v[204:207], v[128:131], v[172:175], v[204:207]
  ds_read_b64_tr_b16 v[64:65], v36 offset:136
  v_mfma_f32_16x16x32_bf16 v[208:211], v[132:135], v[172:175], v[208:211]
  ds_read_b64_tr_b16 v[66:67], v36 offset:128
  v_mfma_f32_16x16x32_bf16 v[212:215], v[136:139], v[172:175], v[212:215]
  ds_read_b128 v[100:103], v37 offset:576
  v_mfma_f32_16x16x32_bf16 v[204:207], v[140:143], v[160:163], v[204:207]
  ds_read_b64_tr_b16 v[68:69], v36 offset:648
  v_mfma_f32_16x16x32_bf16 v[208:211], v[140:143], v[164:167], v[208:211]
  ds_read_b64_tr_b16 v[70:71], v36 offset:640
  v_mfma_f32_16x16x32_bf16 v[212:215], v[140:143], v[168:171], v[212:215]
  ds_read_b128 v[104:107], v37 offset:1088
  v_mfma_f32_16x16x32_bf16 v[216:219], v[140:143], v[172:175], v[216:219]
  ds_read_b64_tr_b16 v[72:73], v36 offset:1160
  s_waitcnt lgkmcnt(15)
  v_mfma_f32_16x16x32_bf16 v[208:211], v[128:131], v[176:179], v[208:211]
  ds_read_b64_tr_b16 v[74:75], v36 offset:1152
  v_mfma_f32_16x16x32_bf16 v[212:215], v[132:135], v[176:179], v[212:215]
  ds_read_b128 v[108:111], v37 offset:1600
  v_mfma_f32_16x16x32_bf16 v[216:219], v[136:139], v[176:179], v[216:219]
  ds_read_b64_tr_b16 v[76:77], v36 offset:1672
  v_mfma_f32_16x16x32_bf16 v[220:223], v[140:143], v[176:179], v[220:223]
  ds_read_b64_tr_b16 v[78:79], v36 offset:1664
  v_mfma_f32_16x16x32_bf16 v[208:211], v[144:147], v[160:163], v[208:211]
  ds_read_b128 v[112:115], v37 offset:2112
  v_mfma_f32_16x16x32_bf16 v[212:215], v[144:147], v[164:167], v[212:215]
  ds_read_b64_tr_b16 v[80:81], v36 offset:2184
  v_mfma_f32_16x16x32_bf16 v[216:219], v[144:147], v[168:171], v[216:219]
  ds_read_b64_tr_b16 v[82:83], v36 offset:2176
  v_mfma_f32_16x16x32_bf16 v[220:223], v[144:147], v[172:175], v[220:223]
  ds_read_b128 v[116:119], v37 offset:2624
  s_waitcnt lgkmcnt(15)
  v_mfma_f32_16x16x32_bf16 v[212:215], v[128:131], v[180:183], v[212:215]
  ds_read_b64_tr_b16 v[84:85], v36 offset:2696
  v_mfma_f32_16x16x32_bf16 v[216:219], v[132:135], v[180:183], v[216:219]
  ds_read_b64_tr_b16 v[86:87], v36 offset:2688
  v_mfma_f32_16x16x32_bf16 v[220:223], v[136:139], v[180:183], v[220:223]
  ds_read_b128 v[120:123], v37 offset:3136
  v_mfma_f32_16x16x32_bf16 v[212:215], v[148:151], v[160:163], v[212:215]
  ds_read_b64_tr_b16 v[88:89], v36 offset:3208
  v_mfma_f32_16x16x32_bf16 v[216:219], v[148:151], v[164:167], v[216:219]
  ds_read_b64_tr_b16 v[90:91], v36 offset:3200
  v_mfma_f32_16x16x32_bf16 v[220:223], v[148:151], v[168:171], v[220:223]
  ds_read_b128 v[124:127], v37 offset:3648
  v_mfma_f32_16x16x32_bf16 v[216:219], v[128:131], v[184:187], v[216:219]
  ds_read_b64_tr_b16 v[92:93], v36 offset:3720
  v_mfma_f32_16x16x32_bf16 v[220:223], v[132:135], v[184:187], v[220:223]
  ds_read_b64_tr_b16 v[94:95], v36 offset:3712
  v_mfma_f32_16x16x32_bf16 v[216:219], v[152:155], v[160:163], v[216:219]
  v_mfma_f32_16x16x32_bf16 v[220:223], v[152:155], v[164:167], v[220:223]
  v_mfma_f32_16x16x32_bf16 v[220:223], v[128:131], v[188:191], v[220:223]
  v_mfma_f32_16x16x32_bf16 v[220:223], v[156:159], v[160:163], v[220:223]
  s_waitcnt lgkmcnt(15)
  v_mfma_f32_16x16x32_bf16 v[192:195], v[64:67], v[96:99], v[192:195]
  v_mfma_f32_16x16x32_bf16 v[196:199], v[64:67], v[100:103], v[196:199]
  v_mfma_f32_16x16x32_bf16 v[196:199], v[68:71], v[96:99], v[196:199]
  v_mfma_f32_16x16x32_bf16 v[200:203], v[68:71], v[100:103], v[200:203]
  v_mfma_f32_16x16x32_bf16 v[200:203], v[64:67], v[104:107], v[200:203]
  v_mfma_f32_16x16x32_bf16 v[204:207], v[68:71], v[104:107], v[204:207]
  v_mfma_f32_16x16x32_bf16 v[200:203], v[72:75], v[96:99], v[200:203]
  v_mfma_f32_16x16x32_bf16 v[204:207], v[72:75], v[100:103], v[204:207]
  v_mfma_f32_16x16x32_bf16 v[208:211], v[72:75], v[104:107], v[208:211]
  ds_read_b128 v[160:163], v37 offset:0
  s_waitcnt lgkmcnt(13)
  v_mfma_f32_16x16x32_bf16 v[204:207], v[64:67], v[108:111], v[204:207]
  ds_read_b64_tr_b16 v[128:129], v36 offset:200
  v_mfma_f32_16x16x32_bf16 v[208:211], v[68:71], v[108:111], v[208:211]
  ds_read_b64_tr_b16 v[130:131], v36 offset:192
  v_mfma_f32_16x16x32_bf16 v[212:215], v[72:75], v[108:111], v[212:215]
  ds_read_b128 v[164:167], v37 offset:512
  v_mfma_f32_16x16x32_bf16 v[204:207], v[76:79], v[96:99], v[204:207]
  ds_read_b64_tr_b16 v[132:133], v36 offset:712
  v_mfma_f32_16x16x32_bf16 v[208:211], v[76:79], v[100:103], v[208:211]
  ds_read_b64_tr_b16 v[134:135], v36 offset:704
  v_mfma_f32_16x16x32_bf16 v[212:215], v[76:79], v[104:107], v[212:215]
  ds_read_b128 v[168:171], v37 offset:1024
  v_mfma_f32_16x16x32_bf16 v[216:219], v[76:79], v[108:111], v[216:219]
  ds_read_b64_tr_b16 v[136:137], v36 offset:1224
  s_waitcnt lgkmcnt(15)
  v_mfma_f32_16x16x32_bf16 v[208:211], v[64:67], v[112:115], v[208:211]
  ds_read_b64_tr_b16 v[138:139], v36 offset:1216
  v_mfma_f32_16x16x32_bf16 v[212:215], v[68:71], v[112:115], v[212:215]
  ds_read_b128 v[172:175], v37 offset:1536
  v_mfma_f32_16x16x32_bf16 v[216:219], v[72:75], v[112:115], v[216:219]
  ds_read_b64_tr_b16 v[140:141], v36 offset:1736
  v_mfma_f32_16x16x32_bf16 v[220:223], v[76:79], v[112:115], v[220:223]
  ds_read_b64_tr_b16 v[142:143], v36 offset:1728
  v_mfma_f32_16x16x32_bf16 v[208:211], v[80:83], v[96:99], v[208:211]
  ds_read_b128 v[176:179], v37 offset:2048
  v_mfma_f32_16x16x32_bf16 v[212:215], v[80:83], v[100:103], v[212:215]
  ds_read_b64_tr_b16 v[144:145], v36 offset:2248
  v_mfma_f32_16x16x32_bf16 v[216:219], v[80:83], v[104:107], v[216:219]
  ds_read_b64_tr_b16 v[146:147], v36 offset:2240
  v_mfma_f32_16x16x32_bf16 v[220:223], v[80:83], v[108:111], v[220:223]
  ds_read_b128 v[180:183], v37 offset:2560
  s_waitcnt lgkmcnt(15)
  v_mfma_f32_16x16x32_bf16 v[212:215], v[64:67], v[116:119], v[212:215]
  ds_read_b64_tr_b16 v[148:149], v36 offset:2760
  v_mfma_f32_16x16x32_bf16 v[216:219], v[68:71], v[116:119], v[216:219]
  ds_read_b64_tr_b16 v[150:151], v36 offset:2752
  v_mfma_f32_16x16x32_bf16 v[220:223], v[72:75], v[116:119], v[220:223]
  ds_read_b128 v[184:187], v37 offset:3072
  v_mfma_f32_16x16x32_bf16 v[212:215], v[84:87], v[96:99], v[212:215]
  ds_read_b64_tr_b16 v[152:153], v36 offset:3272
  v_mfma_f32_16x16x32_bf16 v[216:219], v[84:87], v[100:103], v[216:219]
  ds_read_b64_tr_b16 v[154:155], v36 offset:3264
  v_mfma_f32_16x16x32_bf16 v[220:223], v[84:87], v[104:107], v[220:223]
  ds_read_b128 v[188:191], v37 offset:3584
  v_mfma_f32_16x16x32_bf16 v[216:219], v[64:67], v[120:123], v[216:219]
  ds_read_b64_tr_b16 v[156:157], v36 offset:3784
  v_mfma_f32_16x16x32_bf16 v[220:223], v[68:71], v[120:123], v[220:223]
  ds_read_b64_tr_b16 v[158:159], v36 offset:3776
  v_mfma_f32_16x16x32_bf16 v[216:219], v[88:91], v[96:99], v[216:219]
  v_mfma_f32_16x16x32_bf16 v[220:223], v[88:91], v[100:103], v[220:223]
  v_mfma_f32_16x16x32_bf16 v[220:223], v[64:67], v[124:127], v[220:223]
  v_mfma_f32_16x16x32_bf16 v[220:223], v[92:95], v[96:99], v[220:223]
  s_cmp_lg_u32 s6, 0
  s_cbranch_scc1 S_conv1
  s_waitcnt lgkmcnt(15)
  v_mfma_f32_16x16x32_bf16 v[196:199], v[128:131], v[164:167], v[196:199]
  ds_read_b32 v26, v41
  v_mfma_f32_16x16x32_bf16 v[196:199], v[132:135], v[160:163], v[196:199]
  ds_read_b64 v[2:3], v38 offset:224
  v_mfma_f32_16x16x32_bf16 v[200:203], v[128:131], v[168:171], v[200:203]
  ds_read_b64 v[4:5], v38 offset:1760
  v_mfma_f32_16x16x32_bf16 v[200:203], v[132:135], v[164:167], v[200:203]
  ds_read_b64 v[6:7], v38 offset:2272
  v_mfma_f32_16x16x32_bf16 v[200:203], v[136:139], v[160:163], v[200:203]
  ds_read_b64 v[8:9], v38 offset:3808
  s_waitcnt lgkmcnt(11)
  v_mfma_f32_16x16x32_bf16 v[212:215], v[128:131], v[180:183], v[212:215]
  v_mfma_f32_16x16x32_bf16 v[212:215], v[132:135], v[176:179], v[212:215]
  ds_write_b128 v61, v[196:199] offset:0
  v_mfma_f32_16x16x32_bf16 v[212:215], v[136:139], v[172:175], v[212:215]
  v_mfma_f32_16x16x32_bf16 v[212:215], v[140:143], v[168:171], v[212:215]
  v_mfma_f32_16x16x32_bf16 v[212:215], v[144:147], v[164:167], v[212:215]
  ds_write_b128 v61, v[200:203] offset:1024
  v_mfma_f32_16x16x32_bf16 v[212:215], v[148:151], v[160:163], v[212:215]
  s_waitcnt lgkmcnt(10)
  v_mfma_f32_16x16x32_bf16 v[216:219], v[128:131], v[184:187], v[216:219]
  v_mfma_f32_16x16x32_bf16 v[216:219], v[132:135], v[180:183], v[216:219]
  s_waitcnt lgkmcnt(2)
  v_add_f32 v26, s43, v26
  v_mfma_f32_16x16x32_bf16 v[216:219], v[136:139], v[176:179], v[216:219]
  v_lshlrev_b32 v64, 16, v2
  v_and_b32 v65, s41, v2
  v_mfma_f32_16x16x32_bf16 v[216:219], v[140:143], v[172:175], v[216:219]
  v_lshlrev_b32 v66, 16, v3
  v_and_b32 v67, s41, v3
  v_mfma_f32_16x16x32_bf16 v[216:219], v[144:147], v[168:171], v[216:219]
  ds_write_b128 v61, v[212:215] offset:2048
  v_mfma_f32_16x16x32_bf16 v[216:219], v[148:151], v[164:167], v[216:219]
  v_lshlrev_b32 v68, 16, v4
  v_and_b32 v69, s41, v4
  v_mfma_f32_16x16x32_bf16 v[216:219], v[152:155], v[160:163], v[216:219]
  v_lshlrev_b32 v70, 16, v5
  v_and_b32 v71, s41, v5
  v_mfma_f32_16x16x32_bf16 v[192:195], v[128:131], v[160:163], v[192:195]
  v_lshlrev_b32 v72, 16, v6
  v_and_b32 v73, s41, v6
  v_mfma_f32_16x16x32_bf16 v[204:207], v[128:131], v[172:175], v[204:207]
  v_lshlrev_b32 v74, 16, v7
  v_and_b32 v75, s41, v7
  v_mfma_f32_16x16x32_bf16 v[204:207], v[132:135], v[168:171], v[204:207]
  v_lshlrev_b32 v76, 16, v8
  v_and_b32 v77, s41, v8
  v_mfma_f32_16x16x32_bf16 v[204:207], v[136:139], v[164:167], v[204:207]
  v_lshlrev_b32 v78, 16, v9
  v_and_b32 v79, s41, v9
  v_mfma_f32_16x16x32_bf16 v[204:207], v[140:143], v[160:163], v[204:207]
  ds_write_b128 v61, v[216:219] offset:3072
  ds_write_b32 v58, v58
  v_mfma_f32_16x16x32_bf16 v[208:211], v[128:131], v[176:179], v[208:211]
  v_mfma_f32_16x16x32_bf16 v[208:211], v[132:135], v[172:175], v[208:211]
  v_mfma_f32_16x16x32_bf16 v[208:211], v[136:139], v[168:171], v[208:211]
  v_mfma_f32_16x16x32_bf16 v[208:211], v[140:143], v[164:167], v[208:211]
  v_mfma_f32_16x16x32_bf16 v[208:211], v[144:147], v[160:163], v[208:211]
  v_mfma_f32_16x16x32_bf16 v[220:223], v[128:131], v[188:191], v[220:223]
  v_mfma_f32_16x16x32_bf16 v[220:223], v[132:135], v[184:187], v[220:223]
  v_mfma_f32_16x16x32_bf16 v[220:223], v[136:139], v[180:183], v[220:223]
  v_mfma_f32_16x16x32_bf16 v[220:223], v[140:143], v[176:179], v[220:223]
  ds_read_b32 v28, v27
  ds_read_b128 v[80:83], v40 offset:0
  ds_read_b128 v[84:87], v40 offset:1024
  ds_read_b128 v[88:91], v40 offset:2048
  ds_read_b128 v[92:95], v40 offset:3072
  v_mfma_f32_16x16x32_bf16 v[220:223], v[144:147], v[172:175], v[220:223]
  v_mfma_f32_16x16x32_bf16 v[220:223], v[148:151], v[168:171], v[220:223]
  v_mfma_f32_16x16x32_bf16 v[220:223], v[152:155], v[164:167], v[220:223]
  v_mfma_f32_16x16x32_bf16 v[220:223], v[156:159], v[160:163], v[220:223]
  s_waitcnt lgkmcnt(0)
  v_cmp_eq_u32 vcc, 0, v28
  s_cbranch_vccz S_pok0
S_pw0:
  ds_read_b32 v28, v27
  ds_read_b128 v[80:83], v40 offset:0
  ds_read_b128 v[84:87], v40 offset:1024
  ds_read_b128 v[88:91], v40 offset:2048
  ds_read_b128 v[92:95], v40 offset:3072
  s_waitcnt lgkmcnt(0)
  v_cmp_eq_u32 vcc, 0, v28
  s_cbranch_vccnz S_pw0
S_pok0:
  v_fmac_f32 v80, v26, v64
  v_fmac_f32 v81, v26, v65
  v_fmac_f32 v82, v26, v66
  v_fmac_f32 v83, v26, v67
  v_fmac_f32 v84, v26, v68
  v_fmac_f32 v85, v26, v69
  v_fmac_f32 v86, v26, v70
  v_fmac_f32 v87, v26, v71
  v_fmac_f32 v88, v26, v72
  v_fmac_f32 v89, v26, v73
  v_fmac_f32 v90, v26, v74
  v_fmac_f32 v91, v26, v75
  v_fmac_f32 v92, v26, v76
  v_fmac_f32 v93, v26, v77
  v_fmac_f32 v94, v26, v78
  v_fmac_f32 v95, v26, v79
  s_setprio 3
  v_add_f32 v80, v80, v192
  v_add_f32 v81, v81, v193
  v_add_f32 v82, v82, v194
  v_add_f32 v83, v83, v195
  v_cvt_pk_bf16_f32 v2, v80, v81
  v_cvt_pk_bf16_f32 v3, v82, v83
  ds_write_b64 v39, v[2:3] offset:0
  v_add_f32 v84, v84, v204
  v_add_f32 v85, v85, v205
  v_add_f32 v86, v86, v206
  v_add_f32 v87, v87, v207
  v_cvt_pk_bf16_f32 v4, v84, v85
  v_cvt_pk_bf16_f32 v5, v86, v87
  ds_write_b64 v39, v[4:5] offset:512
  ds_read_b128 v[10:13], v34 offset:0
  v_add_f32 v88, v88, v208
  v_add_f32 v89, v89, v209
  v_add_f32 v90, v90, v210
  v_add_f32 v91, v91, v211
  v_cvt_pk_bf16_f32 v6, v88, v89
  v_cvt_pk_bf16_f32 v7, v90, v91
  ds_write_b64 v39, v[6:7] offset:1024
  v_add_f32 v92, v92, v220
  v_add_f32 v93, v93, v221
  v_add_f32 v94, v94, v222
  v_add_f32 v95, v95, v223
  v_cvt_pk_bf16_f32 v8, v92, v93
  v_cvt_pk_bf16_f32 v9, v94, v95
  ds_write_b64 v39, v[8:9] offset:1536
  ds_read_b128 v[14:17], v34 offset:1024
  s_branch S_done
S_conv1:
  s_waitcnt lgkmcnt(15)
  v_mfma_f32_16x16x32_bf16 v[192:195], v[128:131], v[160:163], v[192:195]
  ds_read_b32 v26, v41
  s_waitcnt lgkmcnt(13)
  v_mfma_f32_16x16x32_bf16 v[204:207], v[128:131], v[172:175], v[204:207]
  ds_read_b64 v[2:3], v38 offset:736
  v_mfma_f32_16x16x32_bf16 v[204:207], v[132:135], v[168:171], v[204:207]
  ds_read_b64 v[4:5], v38 offset:1248
  v_mfma_f32_16x16x32_bf16 v[204:207], v[136:139], v[164:167], v[204:207]
  ds_read_b64 v[6:7], v38 offset:2784
  v_mfma_f32_16x16x32_bf16 v[204:207], v[140:143], v[160:163], v[204:207]
  ds_read_b64 v[8:9], v38 offset:3296
  s_waitcnt lgkmcnt(14)
  v_mfma_f32_16x16x32_bf16 v[208:211], v[128:131], v[176:179], v[208:211]
  ds_write_b128 v61, v[192:195] offset:0
  v_mfma_f32_16x16x32_bf16 v[208:211], v[132:135], v[172:175], v[208:211]
  v_mfma_f32_16x16x32_bf16 v[208:211], v[136:139], v[168:171], v[208:211]
  v_mfma_f32_16x16x32_bf16 v[208:211], v[140:143], v[164:167], v[208:211]
  v_mfma_f32_16x16x32_bf16 v[208:211], v[144:147], v[160:163], v[208:211]
  ds_write_b128 v61, v[204:207] offset:1024
  s_waitcnt lgkmcnt(7)
  v_mfma_f32_16x16x32_bf16 v[220:223], v[128:131], v[188:191], v[220:223]
  v_mfma_f32_16x16x32_bf16 v[220:223], v[132:135], v[184:187], v[220:223]
  v_mfma_f32_16x16x32_bf16 v[220:223], v[136:139], v[180:183], v[220:223]
  s_waitcnt lgkmcnt(2)
  v_add_f32 v26, s43, v26
  v_mfma_f32_16x16x32_bf16 v[220:223], v[140:143], v[176:179], v[220:223]
  v_lshlrev_b32 v64, 16, v2
  v_and_b32 v65, s41, v2
  v_mfma_f32_16x16x32_bf16 v[220:223], v[144:147], v[172:175], v[220:223]
  ds_write_b128 v61, v[208:211] offset:2048
  v_mfma_f32_16x16x32_bf16 v[220:223], v[148:151], v[168:171], v[220:223]
  v_lshlrev_b32 v66, 16, v3
  v_and_b32 v67, s41, v3
  v_mfma_f32_16x16x32_bf16 v[220:223], v[152:155], v[164:167], v[220:223]
  v_lshlrev_b32 v68, 16, v4
  v_and_b32 v69, s41, v4
  v_mfma_f32_16x16x32_bf16 v[220:223], v[156:159], v[160:163], v[220:223]
  v_lshlrev_b32 v70, 16, v5
  v_and_b32 v71, s41, v5
  v_mfma_f32_16x16x32_bf16 v[196:199], v[128:131], v[164:167], v[196:199]
  v_lshlrev_b32 v72, 16, v6
  v_and_b32 v73, s41, v6
  v_mfma_f32_16x16x32_bf16 v[196:199], v[132:135], v[160:163], v[196:199]
  v_lshlrev_b32 v74, 16, v7
  v_and_b32 v75, s41, v7
  v_mfma_f32_16x16x32_bf16 v[200:203], v[128:131], v[168:171], v[200:203]
  v_lshlrev_b32 v76, 16, v8
  v_and_b32 v77, s41, v8
  v_mfma_f32_16x16x32_bf16 v[200:203], v[132:135], v[164:167], v[200:203]
  v_lshlrev_b32 v78, 16, v9
  v_and_b32 v79, s41, v9
  v_mfma_f32_16x16x32_bf16 v[200:203], v[136:139], v[160:163], v[200:203]
  ds_write_b128 v61, v[220:223] offset:3072
  ds_write_b32 v58, v58
  v_mfma_f32_16x16x32_bf16 v[212:215], v[128:131], v[180:183], v[212:215]
  v_mfma_f32_16x16x32_bf16 v[212:215], v[132:135], v[176:179], v[212:215]
  v_mfma_f32_16x16x32_bf16 v[212:215], v[136:139], v[172:175], v[212:215]
  v_mfma_f32_16x16x32_bf16 v[212:215], v[140:143], v[168:171], v[212:215]
  v_mfma_f32_16x16x32_bf16 v[212:215], v[144:147], v[164:167], v[212:215]
  v_mfma_f32_16x16x32_bf16 v[212:215], v[148:151], v[160:163], v[212:215]
  v_mfma_f32_16x16x32_bf16 v[216:219], v[128:131], v[184:187], v[216:219]
  v_mfma_f32_16x16x32_bf16 v[216:219], v[132:135], v[180:183], v[216:219]
  v_mfma_f32_16x16x32_bf16 v[216:219], v[136:139], v[176:179], v[216:219]
  ds_read_b32 v28, v27
  ds_read_b128 v[80:83], v40 offset:0
  ds_read_b128 v[84:87], v40 offset:1024
  ds_read_b128 v[88:91], v40 offset:2048
  ds_read_b128 v[92:95], v40 offset:3072
  v_mfma_f32_16x16x32_bf16 v[216:219], v[140:143], v[172:175], v[216:219]
  v_mfma_f32_16x16x32_bf16 v[216:219], v[144:147], v[168:171], v[216:219]
  v_mfma_f32_16x16x32_bf16 v[216:219], v[148:151], v[164:167], v[216:219]
  v_mfma_f32_16x16x32_bf16 v[216:219], v[152:155], v[160:163], v[216:219]
  s_waitcnt lgkmcnt(0)
  v_cmp_eq_u32 vcc, 0, v28
  s_cbranch_vccz S_pok1
S_pw1:
  ds_read_b32 v28, v27
  ds_read_b128 v[80:83], v40 offset:0
  ds_read_b128 v[84:87], v40 offset:1024
  ds_read_b128 v[88:91], v40 offset:2048
  ds_read_b128 v[92:95], v40 offset:3072
  s_waitcnt lgkmcnt(0)
  v_cmp_eq_u32 vcc, 0, v28
  s_cbranch_vccnz S_pw1
S_pok1:
  v_fmac_f32 v80, v26, v64
  v_fmac_f32 v81, v26, v65
  v_fmac_f32 v82, v26, v66
  v_fmac_f32 v83, v26, v67
  v_fmac_f32 v84, v26, v68
  v_fmac_f32 v85, v26, v69
  v_fmac_f32 v86, v26, v70
  v_fmac_f32 v87, v26, v71
  v_fmac_f32 v88, v26, v72
  v_fmac_f32 v89, v26, v73
  v_fmac_f32 v90, v26, v74
  v_fmac_f32 v91, v26, v75
  v_fmac_f32 v92, v26, v76
  v_fmac_f32 v93, v26, v77
  v_fmac_f32 v94, v26, v78
  v_fmac_f32 v95, v26, v79
  s_setprio 3
  v_add_f32 v80, v80, v196
  v_add_f32 v81, v81, v197
  v_add_f32 v82, v82, v198
  v_add_f32 v83, v83, v199
  v_cvt_pk_bf16_f32 v2, v80, v81
  v_cvt_pk_bf16_f32 v3, v82, v83
  ds_write_b64 v39, v[2:3] offset:0
  v_add_f32 v84, v84, v200
  v_add_f32 v85, v85, v201
  v_add_f32 v86, v86, v202
  v_add_f32 v87, v87, v203
  v_cvt_pk_bf16_f32 v4, v84, v85
  v_cvt_pk_bf16_f32 v5, v86, v87
  ds_write_b64 v39, v[4:5] offset:512
  ds_read_b128 v[10:13], v34 offset:0
  v_add_f32 v88, v88, v212
  v_add_f32 v89, v89, v213
  v_add_f32 v90, v90, v214
  v_add_f32 v91, v91, v215
  v_cvt_pk_bf16_f32 v6, v88, v89
  v_cvt_pk_bf16_f32 v7, v90, v91
  ds_write_b64 v39, v[6:7] offset:1024
  v_add_f32 v92, v92, v216
  v_add_f32 v93, v93, v217
  v_add_f32 v94, v94, v218
  v_add_f32 v95, v95, v219
  v_cvt_pk_bf16_f32 v8, v92, v93
  v_cvt_pk_bf16_f32 v9, v94, v95
  ds_write_b64 v39, v[8:9] offset:1536
  ds_read_b128 v[14:17], v34 offset:1024
S_done:
  s_waitcnt lgkmcnt(3)
  buffer_store_dwordx4 v[10:13], v54, s[12:15], s7 offen offset:0 sc1
  s_waitcnt lgkmcnt(0)
  buffer_store_dwordx4 v[14:17], v54, s[12:15], s7 offen offset:2048 sc1
  s_mov_b64 exec, 1
  s_waitcnt vmcnt(0)
  buffer_store_dwordx2 v[56:57], off, s[12:15], s34 sc1
  s_endpgm
S_tagslow:
  s_load_dwordx2 s[36:37], s[8:9], 192
  s_waitcnt lgkmcnt(0)
  s_cmp_lg_u32 s36, 0
  s_cbranch_scc1 S_tagok
  s_mov_b32 s35, 0
S_tagloop:
  buffer_load_dwordx2 v[52:53], off, s[8:11], 0 sc1
  s_add_u32 s35, s35, 1
  s_waitcnt vmcnt(0)
  v_readfirstlane_b32 s36, v52
  v_readfirstlane_b32 s37, v53
  s_nop 3
  s_cmp_lg_u32 s36, 0
  s_cbranch_scc1 S_tagok
  s_cmp_lt_u32 s35, 100000
  s_cbranch_scc1 S_tagloop
  s_branch S_tagok
S_uslow:
  s_add_u32 s35, s35, 1
  s_cmp_ge_u32 s35, 100000
  s_cbranch_scc1 S_uok
  s_sleep 4
  s_setprio 3
  s_add_u32 s55, s54, 0
  buffer_load_dwordx4 v[232:235], v30, s[12:15], s55 offen sc1
  s_add_u32 s55, s54, 294912
  buffer_load_dwordx4 v[236:239], v30, s[12:15], s55 offen sc1
  s_add_u32 s55, s54, 589824
  buffer_load_dwordx4 v[240:243], v30, s[12:15], s55 offen sc1
  s_add_u32 s55, s54, 884736
  buffer_load_dwordx4 v[244:247], v30, s[12:15], s55 offen sc1
  s_setprio 0
  s_waitcnt vmcnt(0)
  s_branch S_uchk
L_exit:
  s_endpgm
.section .rodata,"a"
.p2align 6
.amdhsa_kernel parallel_sum__ssm_conv_s4__dense_activation_silu__prompt_kernel
  .amdhsa_next_free_vgpr 256
  .amdhsa_next_free_sgpr 102
  .amdhsa_accum_offset 256
  .amdhsa_group_segment_fixed_size 0
  .amdhsa_kernarg_size 120
  .amdhsa_user_sgpr_count 2
  .amdhsa_user_sgpr_kernarg_segment_ptr 1
  .amdhsa_system_sgpr_workgroup_id_x 1
.end_amdhsa_kernel
```
